```python
import torch

def _softmax(x, axis=-1):
    return torch.softmax(x, dim=axis)
def _gelu(x):
    return torch.nn.functional.gelu(x, approximate="tanh")
def _silu(x):
    return torch.nn.functional.silu(x)
def _sigmoid(x):
    return torch.sigmoid(x)
def _layernorm(x, axis=-1, eps=1e-5):
    m = x.mean(dim=axis, keepdim=True)
    v = x.var(dim=axis, keepdim=True, unbiased=False)
    return (x - m) / torch.sqrt(v + eps)
def _scatter_add(tgt, idx, src, axis=0):
    return tgt.clone().index_add_(axis, idx, src)
def _segment_sum(src, seg, n):
    out = torch.zeros((n,) + src.shape[1:], dtype=src.dtype)
    return out.index_add_(0, seg, src)
def _pad(x, pw):
    flat = tuple(v for pair in reversed(pw) for v in pair)
    return torch.nn.functional.pad(x, flat)

kernel_name = 'sequential_preLN__linear_attn_block__mixer_s_mlp__prompt'

def setup_inputs():

    _w = (lambda a: (lambda t: t.to(torch.bfloat16) if t.is_floating_point() else t)(torch.as_tensor(a)))
    def _A_setup():
        B, S, D = 1, 2048, 576
        return {
            "x": _w((lambda *s: torch.randn(*s, dtype=torch.bfloat16) * 0.05)(B, S, D)),
            "wqkv": _w((lambda *s: torch.randn(*s, dtype=torch.bfloat16) * 0.05)(D, 3 * D)),
            "wo": _w((lambda *s: torch.randn(*s, dtype=torch.bfloat16) * 0.05)(D, D)),
        }
    _A_in = _A_setup()

    def _B_setup():
        B, S, D, F = 1, 2048, 576, 4608
        return {
            "x":  _w((lambda *s: torch.randn(*s, dtype=torch.bfloat16) * 0.05)(B, S, D)),
            "w1": _w((lambda *s: torch.randn(*s, dtype=torch.bfloat16) * 3.2)(D, D) * (D ** -0.5)),
            "w2": _w((lambda *s: torch.randn(*s, dtype=torch.bfloat16) * 3.2)(D, D) * (D ** -0.5)),
            "w3": _w((lambda *s: torch.randn(*s, dtype=torch.bfloat16) * 3.2)(D, F) * (D ** -0.5)),
            "w4": _w((lambda *s: torch.randn(*s, dtype=torch.bfloat16) * 1.6)(F, D) * (F ** -0.5)),
        }
    _B_in = _B_setup()

    return {
        "A_x": _A_in["x"],
        "A_wqkv": _A_in["wqkv"],
        "A_wo": _A_in["wo"],
        "B_x": _B_in["x"],
        "B_w1": _B_in["w1"],
        "B_w2": _B_in["w2"],
        "B_w3": _B_in["w3"],
        "B_w4": _B_in["w4"],
    }

def reference(A_x, A_wqkv, A_wo, B_x, B_w1, B_w2, B_w3, B_w4):
    def _A_ref(x, wqkv, wo):
        B, S, D = x.shape
        H = 32; Dh = D // H
        qkv = (lambda x, *d: x.permute(*d))((x @ wqkv).reshape(B, S, 3, H, Dh), 2, 0, 3, 1, 4)
        q, k, v = qkv[0], qkv[1], qkv[2]
        phi = lambda t: torch.where(t > 0, t + 1, torch.exp(t)) + 1e-6
        pq, pk = phi(q), phi(k)
        kv = torch.einsum("bhsd,bhse->bhde", pk, v)
        z = torch.einsum("bhsd->bhd", pk)
        num = torch.einsum("bhqd,bhde->bhqe", pq, kv)
        den = torch.einsum("bhqd,bhd->bhq", pq, z)[..., None] + 1e-6
        o = num / den
        return (lambda x, *d: x.permute(*d))(o, 0, 2, 1, 3).reshape(B, S, D) @ wo

    def _B_ref(x, w1, w2, w3, w4):
        B, S, D = x.shape
        h = _gelu(_layernorm(x, axis=-1) @ w1)
        c = D // 4
        g0 = _pad(h[:, :, 0*c:1*c], ((0, 0), (1, 0), (0, 0)))[:, :S, :]
        g1 = _pad(h[:, :, 1*c:2*c], ((0, 0), (0, 1), (0, 0)))[:, 1:, :]
        g2 = _pad(h[:, :, 2*c:3*c], ((0, 0), (2, 0), (0, 0)))[:, :S, :]
        g3 = _pad(h[:, :, 3*c:   ], ((0, 0), (0, 2), (0, 0)))[:, 2:, :]
        hs = torch.concatenate([g0, g1, g2, g3], axis=-1) @ w2
        x1 = x + hs
        h2 = _gelu(_layernorm(x1, axis=-1) @ w3) @ w4
        return x1 + h2

    x = A_x
    h = x + _A_ref(_layernorm(x, axis=-1), A_wqkv, A_wo)
    h2 = h + _B_ref(_layernorm(h, axis=-1), B_w1, B_w2, B_w3, B_w4)
    return h2
```

```asm
; @launch grid=(256,1,1) block=(768,1,1) lds=163840
.amdgcn_target "amdgcn-amd-amdhsa--gfx950"
.text
.globl sequential_preLN__linear_attn_block__mixer_s_mlp__prompt_kernel
.p2align 8
.type sequential_preLN__linear_attn_block__mixer_s_mlp__prompt_kernel,@function
sequential_preLN__linear_attn_block__mixer_s_mlp__prompt_kernel:
    s_cmp_ge_u32 s2, 256
    s_cbranch_scc1 mega_done
    s_getpc_b64 s[6:7]
    mega_pc0:
    v_lshlrev_b32 v1, 7, v0
    v_cmp_gt_u32 vcc, mega_end-mega_pc0, v1
    s_and_saveexec_b64 s[8:9], vcc
    global_load_dword v165, v1, s[6:7]
    s_mov_b64 exec, s[8:9]
    s_load_dwordx16 s[36:51], s[0:1], 0
    s_load_dwordx4 s[76:79], s[0:1], 64
    s_load_dwordx2 s[4:5], s[0:1], 80
    v_lshrrev_b32 v1, 6, v0
    s_nop 0
    v_readfirstlane_b32 s22, v1
    s_waitcnt lgkmcnt(0)
    s_mov_b64 s[60:61], s[36:37]
    s_mov_b64 s[62:63], s[38:39]
    s_mov_b64 s[64:65], s[40:41]
    s_mov_b64 s[66:67], s[44:45]
    s_mov_b64 s[68:69], s[46:47]
    s_mov_b64 s[70:71], s[48:49]
    s_mov_b64 s[72:73], s[50:51]
    v_mov_b32 v2, 163776
    v_and_b32 v3, 15, v0
    v_lshl_add_u32 v2, v3, 2, v2
    v_mov_b32 v3, 0
    ds_write_b32 v2, v3
    s_add_u32 s84, s4, 0x25b0000
    s_addc_u32 s85, s5, 0
    s_mov_b32 s86, 0x6000
    s_mov_b32 s87, 0x20000
    s_mov_b32 s88, s78
    s_mov_b32 s89, s79
    s_mov_b32 s90, 0x100
    s_mov_b32 s91, 0x20000
    s_cmp_lg_u32 s2, 0
    s_cbranch_scc1 mega_ic1
    v_lshlrev_b32 v1, 4, v0
    v_mov_b32 v4, 0
    v_mov_b32 v5, 0
    v_mov_b32 v6, 0
    v_mov_b32 v7, 0
    buffer_store_dwordx4 v[4:7], v1, s[84:87], 0 offen sc1
    v_add_u32 v1, 12288, v1
    buffer_store_dwordx4 v[4:7], v1, s[84:87], 0 offen sc1
    s_add_u32 s8, s4, 0x28c0000
    s_addc_u32 s9, s5, 0
    s_mov_b32 s10, 0xf000
    s_mov_b32 s11, 0x20000
    v_lshlrev_b32 v1, 4, v0
    buffer_store_dwordx4 v[4:7], v1, s[8:11], 0 offen sc1
    v_add_u32 v1, 12288, v1
    buffer_store_dwordx4 v[4:7], v1, s[8:11], 0 offen sc1
    v_add_u32 v1, 12288, v1
    buffer_store_dwordx4 v[4:7], v1, s[8:11], 0 offen sc1
    v_add_u32 v1, 12288, v1
    buffer_store_dwordx4 v[4:7], v1, s[8:11], 0 offen sc1
    v_add_u32 v1, 12288, v1
    buffer_store_dwordx4 v[4:7], v1, s[8:11], 0 offen sc1
    v_add_u32 v1, 12288, v1
    s_waitcnt vmcnt(0)
    s_barrier
    s_cmp_lg_u32 s22, 0
    s_cbranch_scc1 mega_ic1
    v_mov_b32 v4, 1
    v_mov_b32 v1, 0
    s_mov_b64 exec, 1
    buffer_store_dword v4, v1, s[88:91], 0 offen sc1
    s_mov_b64 exec, -1
mega_ic1:
    s_cmp_ge_u32 s22, 7
    s_cbranch_scc1 mega_ta3
    s_and_b32 s23, s2, 7
    s_lshr_b32 s24, s2, 3
    s_mul_i32 s24, s24, 432
    v_add_u32 v5, s24, v0
    s_and_b32 s25, s23, 1
    s_cmp_eq_u32 s25, 1
    s_cselect_b32 s26, 11, 0
    s_cselect_b32 s27, 7, 12
    s_cselect_b32 s28, 20, 18
    v_lshrrev_b32 v8, 4, v5
    v_and_b32 v9, 15, v5
    v_add_u32 v10, s26, v9
    v_subrev_u32 v11, s27, v9
    v_add_u32 v11, s28, v11
    v_cmp_gt_u32 vcc, s27, v9
    v_mul_u32_u24 v8, 3456, v8
    v_subrev_u32 v12, 9216, v5
    v_cndmask_b32 v10, v11, v10, vcc
    v_min_u32 v10, 26, v10
    v_lshl_add_u32 v8, v10, 7, v8
    v_lshlrev_b32 v12, 7, v12
    s_lshr_b32 s25, s23, 1
    s_mul_i32 s25, s25, 589824
    v_cmp_gt_u32 vcc, 9216, v5
    s_and_saveexec_b64 s[30:31], vcc
    s_cbranch_execz mega_ta3_x
    s_mov_b32 s8, s62
    s_mov_b32 s9, s63
    s_mov_b32 s10, 0x1e6000
    s_mov_b32 s11, 0x20000
    buffer_load_dword v164, v8, s[8:11], 0 offen
mega_ta3_x:
    s_andn2_b64 exec, s[30:31], exec
    s_cbranch_execz mega_ta3_y
    s_mov_b32 s8, s60
    s_mov_b32 s9, s61
    s_mov_b32 s10, 0x240000
    s_mov_b32 s11, 0x20000
    buffer_load_dword v164, v12, s[8:11], s25 offen
mega_ta3_y:
    s_mov_b64 exec, -1
mega_ta3:
    s_cmp_lg_u32 s22, 0
    s_cbranch_scc1 mega_wr4
    v_mov_b32 v1, 0
    s_mov_b32 exec_lo, 0x1
    s_mov_b32 exec_hi, 0x0
    s_mov_b32 s82, 0
mega_pl5:
    buffer_load_dword v2, v1, s[88:91], 0 offen sc1
    s_waitcnt vmcnt(0)
    v_cmp_gt_u32 vcc, 1, v2
    s_add_u32 s82, s82, 1
    s_cmp_gt_u32 s82, 400000
    s_cbranch_scc1 mega_pl5_x
    s_cbranch_vccz mega_pl5_x
    s_sleep 1
    s_branch mega_pl5
mega_pl5_x:
    s_mov_b64 exec, -1
mega_wr4:
    s_cmp_ge_u32 s2, 192
    s_cbranch_scc1 mega_PA2_h
    v_and_b32 v1, 63, v0
    v_lshlrev_b32 v2, 4, v1
    v_and_b32 v3, 15, v1
    v_lshrrev_b32 v4, 4, v1
    s_and_b32 s23, s2, 7
    s_lshr_b32 s24, s2, 3
    s_lshr_b32 s20, s23, 1
    s_lshl_b32 s20, s20, 2
    s_and_b32 s25, s24, 3
    s_add_u32 s20, s20, s25
    s_and_b32 s21, s23, 1
    s_mul_i32 s21, s21, 6
    s_lshr_b32 s25, s24, 2
    s_add_u32 s21, s21, s25
    s_cmp_ge_u32 s22, 8
    s_cbranch_scc1 mega_A6_load
    s_and_b32 s24, s22, 3
    s_lshr_b32 s25, s22, 2
    v_bfe_u32 v5, v3, 1, 3
    v_xor_b32 v124, v4, v5
    v_lshlrev_b32 v124, 4, v124
    v_lshl_add_u32 v124, v3, 7, v124
    v_or_b32 v125, 4, v4
    v_xor_b32 v125, v125, v5
    v_lshlrev_b32 v125, 4, v125
    v_lshl_add_u32 v125, v3, 7, v125
    s_cmp_eq_u32 s25, 1
    s_cselect_b64 vcc, -1, 0
    s_lshl_b32 s26, s24, 12
    s_lshl_b32 s29, s25, 11
    s_add_u32 s30, s26, s29
    s_xor_b32 s29, s29, 2048
    s_add_u32 s31, s26, s29
    v_cndmask_b32 v124, v124, v125, vcc
    v_add_u32 v125, s31, v124
    v_add_u32 v124, s30, v124
    v_lshrrev_b32 v126, 5, v1
    v_lshlrev_b32 v126, 4, v126
    v_bfe_u32 v5, v1, 4, 1
    v_lshl_add_u32 v126, v5, 2, v126
    v_bfe_u32 v5, v1, 2, 2
    v_add_u32 v126, v126, v5
    v_mul_u32_u24 v126, 288, v126
    v_and_b32 v5, 3, v1
    v_lshl_add_u32 v126, v5, 3, v126
    s_mul_i32 s26, s25, 9216
    s_add_u32 s26, s26, 16384
    v_add_u32 v126, s26, v126
    v_mov_b32 v8, 0
    v_mov_b32 v9, 0
    v_mov_b32 v10, 0
    v_mov_b32 v11, 0
    v_mov_b32 v12, 0
    v_mov_b32 v13, 0
    v_mov_b32 v14, 0
    v_mov_b32 v15, 0
    v_mov_b32 v16, 0
    v_mov_b32 v17, 0
    v_mov_b32 v18, 0
    v_mov_b32 v19, 0
    v_mov_b32 v20, 0
    v_mov_b32 v21, 0
    v_mov_b32 v22, 0
    v_mov_b32 v23, 0
    v_mov_b32 v24, 0
    v_mov_b32 v25, 0
    v_mov_b32 v26, 0
    v_mov_b32 v27, 0
    v_mov_b32 v28, 0
    v_mov_b32 v29, 0
    v_mov_b32 v30, 0
    v_mov_b32 v31, 0
    v_mov_b32 v32, 0
    v_mov_b32 v33, 0
    v_mov_b32 v34, 0
    v_mov_b32 v35, 0
    v_mov_b32 v36, 0
    v_mov_b32 v37, 0
    v_mov_b32 v38, 0
    v_mov_b32 v39, 0
    v_mov_b32 v40, 0
    v_mov_b32 v41, 0
    v_mov_b32 v42, 0
    v_mov_b32 v43, 0
    v_mov_b32 v44, 0
    v_mov_b32 v45, 0
    v_mov_b32 v46, 0
    v_mov_b32 v47, 0
    v_mov_b32 v48, 0
    v_mov_b32 v49, 0
    v_mov_b32 v50, 0
    v_mov_b32 v51, 0
    v_mov_b32 v52, 0
    v_mov_b32 v53, 0
    v_mov_b32 v54, 0
    v_mov_b32 v55, 0
    v_mov_b32 v56, 0
    v_mov_b32 v57, 0
    v_mov_b32 v58, 0
    v_mov_b32 v59, 0
    v_mov_b32 v60, 0
    v_mov_b32 v61, 0
    v_mov_b32 v62, 0
    v_mov_b32 v63, 0
    v_mov_b32 v64, 0
    v_mov_b32 v65, 0
    v_mov_b32 v66, 0
    v_mov_b32 v67, 0
    v_mov_b32 v68, 0
    v_mov_b32 v69, 0
    v_mov_b32 v70, 0
    v_mov_b32 v71, 0
    v_mov_b32 v72, 0
    v_mov_b32 v73, 0
    v_mov_b32 v74, 0
    v_mov_b32 v75, 0
    v_mov_b32 v76, 0
    v_mov_b32 v77, 0
    v_mov_b32 v78, 0
    v_mov_b32 v79, 0
    s_mov_b32 s33, 0x3f803f80
    s_mov_b32 s27, 0
    s_cmp_ge_u32 s21, 4
    s_cbranch_scc1 mega_A6_kvloop
    s_barrier
    s_and_b32 s28, s27, 3
    s_mul_i32 s28, s28, 34816
    v_add_u32 v5, s28, v124
    v_add_u32 v7, s28, v125
    v_add_u32 v6, s28, v126
    ds_read_b128 v[116:119], v5
    ds_read_b128 v[120:123], v7
    ds_read_b64_tr_b16 v[80:81], v6 offset:0
    ds_read_b64_tr_b16 v[82:83], v6 offset:2304
    ds_read_b64_tr_b16 v[84:85], v6 offset:32
    ds_read_b64_tr_b16 v[86:87], v6 offset:2336
    ds_read_b64_tr_b16 v[88:89], v6 offset:64
    ds_read_b64_tr_b16 v[90:91], v6 offset:2368
    ds_read_b64_tr_b16 v[92:93], v6 offset:96
    ds_read_b64_tr_b16 v[94:95], v6 offset:2400
    ds_read_b64_tr_b16 v[96:97], v6 offset:128
    ds_read_b64_tr_b16 v[98:99], v6 offset:2432
    ds_read_b64_tr_b16 v[100:101], v6 offset:160
    ds_read_b64_tr_b16 v[102:103], v6 offset:2464
    ds_read_b64_tr_b16 v[104:105], v6 offset:192
    ds_read_b64_tr_b16 v[106:107], v6 offset:2496
    ds_read_b64_tr_b16 v[108:109], v6 offset:224
    ds_read_b64_tr_b16 v[110:111], v6 offset:2528
    ds_read_b64_tr_b16 v[112:113], v6 offset:256
    ds_read_b64_tr_b16 v[114:115], v6 offset:2560
mega_A6_ql:
    s_add_u32 s29, s27, 1
    s_and_b32 s28, s29, 3
    s_mul_i32 s28, s28, 34816
    v_add_u32 v5, s28, v124
    v_add_u32 v7, s28, v125
    v_add_u32 v6, s28, v126
    s_barrier
    ds_read_b128 v[136:139], v5
    ds_read_b128 v[140:143], v7
    s_waitcnt lgkmcnt(15)
    v_mfma_f32_16x16x32_bf16 v[8:11], v[80:83], v[116:119], v[8:11]
    v_mfma_f32_16x16x32_bf16 v[44:47], v[80:83], v[120:123], v[44:47]
    ds_read_b64_tr_b16 v[80:81], v6 offset:0
    ds_read_b64_tr_b16 v[82:83], v6 offset:2304
    s_waitcnt lgkmcnt(15)
    v_mfma_f32_16x16x32_bf16 v[12:15], v[84:87], v[116:119], v[12:15]
    v_mfma_f32_16x16x32_bf16 v[48:51], v[84:87], v[120:123], v[48:51]
    ds_read_b64_tr_b16 v[84:85], v6 offset:32
    ds_read_b64_tr_b16 v[86:87], v6 offset:2336
    s_waitcnt lgkmcnt(15)
    v_mfma_f32_16x16x32_bf16 v[16:19], v[88:91], v[116:119], v[16:19]
    v_mfma_f32_16x16x32_bf16 v[52:55], v[88:91], v[120:123], v[52:55]
    ds_read_b64_tr_b16 v[88:89], v6 offset:64
    ds_read_b64_tr_b16 v[90:91], v6 offset:2368
    s_waitcnt lgkmcnt(15)
    v_mfma_f32_16x16x32_bf16 v[20:23], v[92:95], v[116:119], v[20:23]
    v_mfma_f32_16x16x32_bf16 v[56:59], v[92:95], v[120:123], v[56:59]
    ds_read_b64_tr_b16 v[92:93], v6 offset:96
    ds_read_b64_tr_b16 v[94:95], v6 offset:2400
    s_waitcnt lgkmcnt(15)
    v_mfma_f32_16x16x32_bf16 v[24:27], v[96:99], v[116:119], v[24:27]
    v_mfma_f32_16x16x32_bf16 v[60:63], v[96:99], v[120:123], v[60:63]
    ds_read_b64_tr_b16 v[96:97], v6 offset:128
    ds_read_b64_tr_b16 v[98:99], v6 offset:2432
    s_waitcnt lgkmcnt(15)
    v_mfma_f32_16x16x32_bf16 v[28:31], v[100:103], v[116:119], v[28:31]
    v_mfma_f32_16x16x32_bf16 v[64:67], v[100:103], v[120:123], v[64:67]
    ds_read_b64_tr_b16 v[100:101], v6 offset:160
    ds_read_b64_tr_b16 v[102:103], v6 offset:2464
    s_waitcnt lgkmcnt(15)
    v_mfma_f32_16x16x32_bf16 v[32:35], v[104:107], v[116:119], v[32:35]
    v_mfma_f32_16x16x32_bf16 v[68:71], v[104:107], v[120:123], v[68:71]
    ds_read_b64_tr_b16 v[104:105], v6 offset:192
    ds_read_b64_tr_b16 v[106:107], v6 offset:2496
    s_waitcnt lgkmcnt(15)
    v_mfma_f32_16x16x32_bf16 v[36:39], v[108:111], v[116:119], v[36:39]
    v_mfma_f32_16x16x32_bf16 v[72:75], v[108:111], v[120:123], v[72:75]
    ds_read_b64_tr_b16 v[108:109], v6 offset:224
    ds_read_b64_tr_b16 v[110:111], v6 offset:2528
    s_waitcnt lgkmcnt(15)
    v_mfma_f32_16x16x32_bf16 v[40:43], v[112:115], v[116:119], v[40:43]
    v_mfma_f32_16x16x32_bf16 v[76:79], v[112:115], v[120:123], v[76:79]
    ds_read_b64_tr_b16 v[112:113], v6 offset:256
    ds_read_b64_tr_b16 v[114:115], v6 offset:2560
    s_add_u32 s27, s27, 1
    s_add_u32 s29, s27, 1
    s_and_b32 s28, s29, 3
    s_mul_i32 s28, s28, 34816
    v_add_u32 v5, s28, v124
    v_add_u32 v7, s28, v125
    v_add_u32 v6, s28, v126
    s_barrier
    ds_read_b128 v[116:119], v5
    ds_read_b128 v[120:123], v7
    s_waitcnt lgkmcnt(15)
    v_mfma_f32_16x16x32_bf16 v[8:11], v[80:83], v[136:139], v[8:11]
    v_mfma_f32_16x16x32_bf16 v[44:47], v[80:83], v[140:143], v[44:47]
    ds_read_b64_tr_b16 v[80:81], v6 offset:0
    ds_read_b64_tr_b16 v[82:83], v6 offset:2304
    s_waitcnt lgkmcnt(15)
    v_mfma_f32_16x16x32_bf16 v[12:15], v[84:87], v[136:139], v[12:15]
    v_mfma_f32_16x16x32_bf16 v[48:51], v[84:87], v[140:143], v[48:51]
    ds_read_b64_tr_b16 v[84:85], v6 offset:32
    ds_read_b64_tr_b16 v[86:87], v6 offset:2336
    s_waitcnt lgkmcnt(15)
    v_mfma_f32_16x16x32_bf16 v[16:19], v[88:91], v[136:139], v[16:19]
    v_mfma_f32_16x16x32_bf16 v[52:55], v[88:91], v[140:143], v[52:55]
    ds_read_b64_tr_b16 v[88:89], v6 offset:64
    ds_read_b64_tr_b16 v[90:91], v6 offset:2368
    s_waitcnt lgkmcnt(15)
    v_mfma_f32_16x16x32_bf16 v[20:23], v[92:95], v[136:139], v[20:23]
    v_mfma_f32_16x16x32_bf16 v[56:59], v[92:95], v[140:143], v[56:59]
    ds_read_b64_tr_b16 v[92:93], v6 offset:96
    ds_read_b64_tr_b16 v[94:95], v6 offset:2400
    s_waitcnt lgkmcnt(15)
    v_mfma_f32_16x16x32_bf16 v[24:27], v[96:99], v[136:139], v[24:27]
    v_mfma_f32_16x16x32_bf16 v[60:63], v[96:99], v[140:143], v[60:63]
    ds_read_b64_tr_b16 v[96:97], v6 offset:128
    ds_read_b64_tr_b16 v[98:99], v6 offset:2432
    s_waitcnt lgkmcnt(15)
    v_mfma_f32_16x16x32_bf16 v[28:31], v[100:103], v[136:139], v[28:31]
    v_mfma_f32_16x16x32_bf16 v[64:67], v[100:103], v[140:143], v[64:67]
    ds_read_b64_tr_b16 v[100:101], v6 offset:160
    ds_read_b64_tr_b16 v[102:103], v6 offset:2464
    s_waitcnt lgkmcnt(15)
    v_mfma_f32_16x16x32_bf16 v[32:35], v[104:107], v[136:139], v[32:35]
    v_mfma_f32_16x16x32_bf16 v[68:71], v[104:107], v[140:143], v[68:71]
    ds_read_b64_tr_b16 v[104:105], v6 offset:192
    ds_read_b64_tr_b16 v[106:107], v6 offset:2496
    s_waitcnt lgkmcnt(15)
    v_mfma_f32_16x16x32_bf16 v[36:39], v[108:111], v[136:139], v[36:39]
    v_mfma_f32_16x16x32_bf16 v[72:75], v[108:111], v[140:143], v[72:75]
    ds_read_b64_tr_b16 v[108:109], v6 offset:224
    ds_read_b64_tr_b16 v[110:111], v6 offset:2528
    s_waitcnt lgkmcnt(15)
    v_mfma_f32_16x16x32_bf16 v[40:43], v[112:115], v[136:139], v[40:43]
    v_mfma_f32_16x16x32_bf16 v[76:79], v[112:115], v[140:143], v[76:79]
    ds_read_b64_tr_b16 v[112:113], v6 offset:256
    ds_read_b64_tr_b16 v[114:115], v6 offset:2560
    s_add_u32 s27, s27, 1
    s_cmp_lt_u32 s27, 8
    s_cbranch_scc1 mega_A6_ql
    s_waitcnt lgkmcnt(15)
    v_mfma_f32_16x16x32_bf16 v[8:11], v[80:83], v[116:119], v[8:11]
    v_mfma_f32_16x16x32_bf16 v[44:47], v[80:83], v[120:123], v[44:47]
    s_waitcnt lgkmcnt(14)
    v_mfma_f32_16x16x32_bf16 v[12:15], v[84:87], v[116:119], v[12:15]
    v_mfma_f32_16x16x32_bf16 v[48:51], v[84:87], v[120:123], v[48:51]
    s_waitcnt lgkmcnt(12)
    v_mfma_f32_16x16x32_bf16 v[16:19], v[88:91], v[116:119], v[16:19]
    v_mfma_f32_16x16x32_bf16 v[52:55], v[88:91], v[120:123], v[52:55]
    s_waitcnt lgkmcnt(10)
    v_mfma_f32_16x16x32_bf16 v[20:23], v[92:95], v[116:119], v[20:23]
    v_mfma_f32_16x16x32_bf16 v[56:59], v[92:95], v[120:123], v[56:59]
    s_waitcnt lgkmcnt(8)
    v_mfma_f32_16x16x32_bf16 v[24:27], v[96:99], v[116:119], v[24:27]
    v_mfma_f32_16x16x32_bf16 v[60:63], v[96:99], v[120:123], v[60:63]
    s_waitcnt lgkmcnt(6)
    v_mfma_f32_16x16x32_bf16 v[28:31], v[100:103], v[116:119], v[28:31]
    v_mfma_f32_16x16x32_bf16 v[64:67], v[100:103], v[120:123], v[64:67]
    s_waitcnt lgkmcnt(4)
    v_mfma_f32_16x16x32_bf16 v[32:35], v[104:107], v[116:119], v[32:35]
    v_mfma_f32_16x16x32_bf16 v[68:71], v[104:107], v[120:123], v[68:71]
    s_waitcnt lgkmcnt(2)
    v_mfma_f32_16x16x32_bf16 v[36:39], v[108:111], v[116:119], v[36:39]
    v_mfma_f32_16x16x32_bf16 v[72:75], v[108:111], v[120:123], v[72:75]
    s_waitcnt lgkmcnt(0)
    v_mfma_f32_16x16x32_bf16 v[40:43], v[112:115], v[116:119], v[40:43]
    v_mfma_f32_16x16x32_bf16 v[76:79], v[112:115], v[120:123], v[76:79]
    s_branch mega_A6_cdone
mega_A6_kvloop:
    s_barrier
    s_and_b32 s28, s27, 3
    s_mul_i32 s28, s28, 34816
    v_add_u32 v5, s28, v124
    v_add_u32 v7, s28, v125
    v_add_u32 v6, s28, v126
    ds_read_b128 v[116:119], v5
    ds_read_b128 v[120:123], v7
    ds_read_b64_tr_b16 v[80:81], v6 offset:0
    ds_read_b64_tr_b16 v[82:83], v6 offset:2304
    ds_read_b64_tr_b16 v[84:85], v6 offset:32
    ds_read_b64_tr_b16 v[86:87], v6 offset:2336
    ds_read_b64_tr_b16 v[88:89], v6 offset:64
    ds_read_b64_tr_b16 v[90:91], v6 offset:2368
    ds_read_b64_tr_b16 v[92:93], v6 offset:96
    ds_read_b64_tr_b16 v[94:95], v6 offset:2400
    ds_read_b64_tr_b16 v[96:97], v6 offset:128
    ds_read_b64_tr_b16 v[98:99], v6 offset:2432
    ds_read_b64_tr_b16 v[100:101], v6 offset:160
    ds_read_b64_tr_b16 v[102:103], v6 offset:2464
    ds_read_b64_tr_b16 v[104:105], v6 offset:192
    ds_read_b64_tr_b16 v[106:107], v6 offset:2496
    ds_read_b64_tr_b16 v[108:109], v6 offset:224
    ds_read_b64_tr_b16 v[110:111], v6 offset:2528
    ds_read_b64_tr_b16 v[112:113], v6 offset:256
    ds_read_b64_tr_b16 v[114:115], v6 offset:2560
mega_A6_kvl:
    s_add_u32 s29, s27, 1
    s_and_b32 s28, s29, 3
    s_mul_i32 s28, s28, 34816
    v_add_u32 v5, s28, v124
    v_add_u32 v7, s28, v125
    v_add_u32 v6, s28, v126
    s_barrier
    ds_read_b128 v[136:139], v5
    ds_read_b128 v[140:143], v7
    s_waitcnt lgkmcnt(15)
    v_mfma_f32_16x16x32_bf16 v[8:11], v[116:119], v[80:83], v[8:11]
    v_mfma_f32_16x16x32_bf16 v[44:47], v[120:123], v[80:83], v[44:47]
    ds_read_b64_tr_b16 v[80:81], v6 offset:0
    ds_read_b64_tr_b16 v[82:83], v6 offset:2304
    s_waitcnt lgkmcnt(15)
    v_mfma_f32_16x16x32_bf16 v[12:15], v[116:119], v[84:87], v[12:15]
    v_mfma_f32_16x16x32_bf16 v[48:51], v[120:123], v[84:87], v[48:51]
    ds_read_b64_tr_b16 v[84:85], v6 offset:32
    ds_read_b64_tr_b16 v[86:87], v6 offset:2336
    s_waitcnt lgkmcnt(15)
    v_mfma_f32_16x16x32_bf16 v[16:19], v[116:119], v[88:91], v[16:19]
    v_mfma_f32_16x16x32_bf16 v[52:55], v[120:123], v[88:91], v[52:55]
    ds_read_b64_tr_b16 v[88:89], v6 offset:64
    ds_read_b64_tr_b16 v[90:91], v6 offset:2368
    s_waitcnt lgkmcnt(15)
    v_mfma_f32_16x16x32_bf16 v[20:23], v[116:119], v[92:95], v[20:23]
    v_mfma_f32_16x16x32_bf16 v[56:59], v[120:123], v[92:95], v[56:59]
    ds_read_b64_tr_b16 v[92:93], v6 offset:96
    ds_read_b64_tr_b16 v[94:95], v6 offset:2400
    s_waitcnt lgkmcnt(15)
    v_mfma_f32_16x16x32_bf16 v[24:27], v[116:119], v[96:99], v[24:27]
    v_mfma_f32_16x16x32_bf16 v[60:63], v[120:123], v[96:99], v[60:63]
    ds_read_b64_tr_b16 v[96:97], v6 offset:128
    ds_read_b64_tr_b16 v[98:99], v6 offset:2432
    s_waitcnt lgkmcnt(15)
    v_mfma_f32_16x16x32_bf16 v[28:31], v[116:119], v[100:103], v[28:31]
    v_mfma_f32_16x16x32_bf16 v[64:67], v[120:123], v[100:103], v[64:67]
    ds_read_b64_tr_b16 v[100:101], v6 offset:160
    ds_read_b64_tr_b16 v[102:103], v6 offset:2464
    s_waitcnt lgkmcnt(15)
    v_mfma_f32_16x16x32_bf16 v[32:35], v[116:119], v[104:107], v[32:35]
    v_mfma_f32_16x16x32_bf16 v[68:71], v[120:123], v[104:107], v[68:71]
    ds_read_b64_tr_b16 v[104:105], v6 offset:192
    ds_read_b64_tr_b16 v[106:107], v6 offset:2496
    s_waitcnt lgkmcnt(15)
    v_mfma_f32_16x16x32_bf16 v[36:39], v[116:119], v[108:111], v[36:39]
    v_mfma_f32_16x16x32_bf16 v[72:75], v[120:123], v[108:111], v[72:75]
    ds_read_b64_tr_b16 v[108:109], v6 offset:224
    ds_read_b64_tr_b16 v[110:111], v6 offset:2528
    s_waitcnt lgkmcnt(15)
    v_mfma_f32_16x16x32_bf16 v[40:43], v[116:119], v[112:115], v[40:43]
    v_mfma_f32_16x16x32_bf16 v[76:79], v[120:123], v[112:115], v[76:79]
    ds_read_b64_tr_b16 v[112:113], v6 offset:256
    ds_read_b64_tr_b16 v[114:115], v6 offset:2560
    s_add_u32 s27, s27, 1
    s_add_u32 s29, s27, 1
    s_and_b32 s28, s29, 3
    s_mul_i32 s28, s28, 34816
    v_add_u32 v5, s28, v124
    v_add_u32 v7, s28, v125
    v_add_u32 v6, s28, v126
    s_barrier
    ds_read_b128 v[116:119], v5
    ds_read_b128 v[120:123], v7
    s_waitcnt lgkmcnt(15)
    v_mfma_f32_16x16x32_bf16 v[8:11], v[136:139], v[80:83], v[8:11]
    v_mfma_f32_16x16x32_bf16 v[44:47], v[140:143], v[80:83], v[44:47]
    ds_read_b64_tr_b16 v[80:81], v6 offset:0
    ds_read_b64_tr_b16 v[82:83], v6 offset:2304
    s_waitcnt lgkmcnt(15)
    v_mfma_f32_16x16x32_bf16 v[12:15], v[136:139], v[84:87], v[12:15]
    v_mfma_f32_16x16x32_bf16 v[48:51], v[140:143], v[84:87], v[48:51]
    ds_read_b64_tr_b16 v[84:85], v6 offset:32
    ds_read_b64_tr_b16 v[86:87], v6 offset:2336
    s_waitcnt lgkmcnt(15)
    v_mfma_f32_16x16x32_bf16 v[16:19], v[136:139], v[88:91], v[16:19]
    v_mfma_f32_16x16x32_bf16 v[52:55], v[140:143], v[88:91], v[52:55]
    ds_read_b64_tr_b16 v[88:89], v6 offset:64
    ds_read_b64_tr_b16 v[90:91], v6 offset:2368
    s_waitcnt lgkmcnt(15)
    v_mfma_f32_16x16x32_bf16 v[20:23], v[136:139], v[92:95], v[20:23]
    v_mfma_f32_16x16x32_bf16 v[56:59], v[140:143], v[92:95], v[56:59]
    ds_read_b64_tr_b16 v[92:93], v6 offset:96
    ds_read_b64_tr_b16 v[94:95], v6 offset:2400
    s_waitcnt lgkmcnt(15)
    v_mfma_f32_16x16x32_bf16 v[24:27], v[136:139], v[96:99], v[24:27]
    v_mfma_f32_16x16x32_bf16 v[60:63], v[140:143], v[96:99], v[60:63]
    ds_read_b64_tr_b16 v[96:97], v6 offset:128
    ds_read_b64_tr_b16 v[98:99], v6 offset:2432
    s_waitcnt lgkmcnt(15)
    v_mfma_f32_16x16x32_bf16 v[28:31], v[136:139], v[100:103], v[28:31]
    v_mfma_f32_16x16x32_bf16 v[64:67], v[140:143], v[100:103], v[64:67]
    ds_read_b64_tr_b16 v[100:101], v6 offset:160
    ds_read_b64_tr_b16 v[102:103], v6 offset:2464
    s_waitcnt lgkmcnt(15)
    v_mfma_f32_16x16x32_bf16 v[32:35], v[136:139], v[104:107], v[32:35]
    v_mfma_f32_16x16x32_bf16 v[68:71], v[140:143], v[104:107], v[68:71]
    ds_read_b64_tr_b16 v[104:105], v6 offset:192
    ds_read_b64_tr_b16 v[106:107], v6 offset:2496
    s_waitcnt lgkmcnt(15)
    v_mfma_f32_16x16x32_bf16 v[36:39], v[136:139], v[108:111], v[36:39]
    v_mfma_f32_16x16x32_bf16 v[72:75], v[140:143], v[108:111], v[72:75]
    ds_read_b64_tr_b16 v[108:109], v6 offset:224
    ds_read_b64_tr_b16 v[110:111], v6 offset:2528
    s_waitcnt lgkmcnt(15)
    v_mfma_f32_16x16x32_bf16 v[40:43], v[136:139], v[112:115], v[40:43]
    v_mfma_f32_16x16x32_bf16 v[76:79], v[140:143], v[112:115], v[76:79]
    ds_read_b64_tr_b16 v[112:113], v6 offset:256
    ds_read_b64_tr_b16 v[114:115], v6 offset:2560
    s_add_u32 s27, s27, 1
    s_cmp_lt_u32 s27, 8
    s_cbranch_scc1 mega_A6_kvl
    s_waitcnt lgkmcnt(15)
    v_mfma_f32_16x16x32_bf16 v[8:11], v[116:119], v[80:83], v[8:11]
    v_mfma_f32_16x16x32_bf16 v[44:47], v[120:123], v[80:83], v[44:47]
    s_waitcnt lgkmcnt(14)
    v_mfma_f32_16x16x32_bf16 v[12:15], v[116:119], v[84:87], v[12:15]
    v_mfma_f32_16x16x32_bf16 v[48:51], v[120:123], v[84:87], v[48:51]
    s_waitcnt lgkmcnt(12)
    v_mfma_f32_16x16x32_bf16 v[16:19], v[116:119], v[88:91], v[16:19]
    v_mfma_f32_16x16x32_bf16 v[52:55], v[120:123], v[88:91], v[52:55]
    s_waitcnt lgkmcnt(10)
    v_mfma_f32_16x16x32_bf16 v[20:23], v[116:119], v[92:95], v[20:23]
    v_mfma_f32_16x16x32_bf16 v[56:59], v[120:123], v[92:95], v[56:59]
    s_waitcnt lgkmcnt(8)
    v_mfma_f32_16x16x32_bf16 v[24:27], v[116:119], v[96:99], v[24:27]
    v_mfma_f32_16x16x32_bf16 v[60:63], v[120:123], v[96:99], v[60:63]
    s_waitcnt lgkmcnt(6)
    v_mfma_f32_16x16x32_bf16 v[28:31], v[116:119], v[100:103], v[28:31]
    v_mfma_f32_16x16x32_bf16 v[64:67], v[120:123], v[100:103], v[64:67]
    s_waitcnt lgkmcnt(4)
    v_mfma_f32_16x16x32_bf16 v[32:35], v[116:119], v[104:107], v[32:35]
    v_mfma_f32_16x16x32_bf16 v[68:71], v[120:123], v[104:107], v[68:71]
    s_waitcnt lgkmcnt(2)
    v_mfma_f32_16x16x32_bf16 v[36:39], v[116:119], v[108:111], v[36:39]
    v_mfma_f32_16x16x32_bf16 v[72:75], v[120:123], v[108:111], v[72:75]
    s_waitcnt lgkmcnt(0)
    v_mfma_f32_16x16x32_bf16 v[40:43], v[116:119], v[112:115], v[40:43]
    v_mfma_f32_16x16x32_bf16 v[76:79], v[120:123], v[112:115], v[76:79]
mega_A6_cdone:
    s_waitcnt vmcnt(0) lgkmcnt(0)
    s_barrier
    s_mul_i32 s28, s22, 9216
    v_add_u32 v5, s28, v2
    ds_write_b128 v5, v[44:47] offset:0
    ds_write_b128 v5, v[48:51] offset:1024
    ds_write_b128 v5, v[52:55] offset:2048
    ds_write_b128 v5, v[56:59] offset:3072
    ds_write_b128 v5, v[60:63] offset:4096
    ds_write_b128 v5, v[64:67] offset:5120
    ds_write_b128 v5, v[68:71] offset:6144
    ds_write_b128 v5, v[72:75] offset:7168
    ds_write_b128 v5, v[76:79] offset:8192
    s_waitcnt lgkmcnt(0)
    s_barrier
    s_xor_b32 s28, s22, 4
    s_mul_i32 s28, s28, 9216
    v_add_u32 v5, s28, v2
    ds_read_b128 v[44:47], v5 offset:0
    ds_read_b128 v[48:51], v5 offset:1024
    ds_read_b128 v[52:55], v5 offset:2048
    ds_read_b128 v[56:59], v5 offset:3072
    ds_read_b128 v[60:63], v5 offset:4096
    ds_read_b128 v[64:67], v5 offset:5120
    ds_read_b128 v[68:71], v5 offset:6144
    ds_read_b128 v[72:75], v5 offset:7168
    ds_read_b128 v[76:79], v5 offset:8192
    s_lshl_b32 s26, s24, 1
    s_add_u32 s26, s26, s25
    s_cmp_ge_u32 s21, 4
    s_cbranch_scc1 mega_A6_kvepi
    s_lshl_b32 s28, s26, 7
    s_add_u32 s28, s28, 139264
    v_lshl_add_u32 v5, v3, 3, s28
    ds_read_b64 v[80:81], v5
    ds_read_b64 v[82:83], v5 offset:1024
    v_lshlrev_b32 v6, 4, v4
    v_add_u32 v6, 139264, v6
    ds_read_b128 v[84:87], v6 offset:2048
    ds_read_b128 v[88:91], v6 offset:2112
    ds_read_b128 v[92:95], v6 offset:2176
    ds_read_b128 v[96:99], v6 offset:2240
    ds_read_b128 v[100:103], v6 offset:2304
    ds_read_b128 v[104:107], v6 offset:2368
    ds_read_b128 v[108:111], v6 offset:2432
    ds_read_b128 v[112:115], v6 offset:2496
    ds_read_b128 v[116:119], v6 offset:2560
    s_waitcnt lgkmcnt(0)
    v_add_f32 v8, v8, v44
    v_add_f32 v9, v9, v45
    v_add_f32 v10, v10, v46
    v_add_f32 v11, v11, v47
    v_add_f32 v12, v12, v48
    v_add_f32 v13, v13, v49
    v_add_f32 v14, v14, v50
    v_add_f32 v15, v15, v51
    v_add_f32 v16, v16, v52
    v_add_f32 v17, v17, v53
    v_add_f32 v18, v18, v54
    v_add_f32 v19, v19, v55
    v_add_f32 v20, v20, v56
    v_add_f32 v21, v21, v57
    v_add_f32 v22, v22, v58
    v_add_f32 v23, v23, v59
    v_add_f32 v24, v24, v60
    v_add_f32 v25, v25, v61
    v_add_f32 v26, v26, v62
    v_add_f32 v27, v27, v63
    v_add_f32 v28, v28, v64
    v_add_f32 v29, v29, v65
    v_add_f32 v30, v30, v66
    v_add_f32 v31, v31, v67
    v_add_f32 v32, v32, v68
    v_add_f32 v33, v33, v69
    v_add_f32 v34, v34, v70
    v_add_f32 v35, v35, v71
    v_add_f32 v36, v36, v72
    v_add_f32 v37, v37, v73
    v_add_f32 v38, v38, v74
    v_add_f32 v39, v39, v75
    v_add_f32 v40, v40, v76
    v_add_f32 v41, v41, v77
    v_add_f32 v42, v42, v78
    v_add_f32 v43, v43, v79
    v_add_f32 v80, v80, v82
    v_add_f32 v81, v81, v83
    v_mul_f32 v80, 0x3ae38e39, v80
    v_mul_f32 v81, 0x3ae38e39, v81
    v_fma_f32 v81, -v80, v80, v81
    v_max_f32 v81, 0, v81
    v_add_f32 v81, 0x3727c5ac, v81
    v_rsq_f32 v81, v81
    s_nop 0
    ds_read_b128 v[44:47], v6 offset:2688
    ds_read_b128 v[48:51], v6 offset:2752
    ds_read_b128 v[52:55], v6 offset:2816
    ds_read_b128 v[56:59], v6 offset:2880
    ds_read_b128 v[60:63], v6 offset:2944
    ds_read_b128 v[64:67], v6 offset:3008
    ds_read_b128 v[68:71], v6 offset:3072
    ds_read_b128 v[72:75], v6 offset:3136
    ds_read_b128 v[76:79], v6 offset:3200
    s_mul_i32 s29, s22, 6144
    s_add_u32 s29, s29, 73728
    v_add_u32 v7, s29, v2
    v_mov_b32 v124, 0
    v_mov_b32 v125, 0
    v_mov_b32 v126, 0
    v_mov_b32 v127, 0
    ds_write_b128 v7, v[124:127] offset:0
    ds_write_b128 v7, v[124:127] offset:1024
    ds_write_b128 v7, v[124:127] offset:2048
    ds_write_b128 v7, v[124:127] offset:3072
    ds_write_b128 v7, v[124:127] offset:4096
    ds_write_b128 v7, v[124:127] offset:5120
    v_lshlrev_b32 v6, 3, v4
    v_add_u32 v6, 139264, v6
    ds_read_b32 v140, v6 offset:3328
    ds_read_b32 v141, v6 offset:3332
    ds_read_b32 v142, v6 offset:3360
    ds_read_b32 v143, v6 offset:3364
    ds_read_b32 v144, v6 offset:3392
    ds_read_b32 v145, v6 offset:3396
    ds_read_b32 v146, v6 offset:3424
    ds_read_b32 v147, v6 offset:3428
    ds_read_b32 v148, v6 offset:3456
    ds_read_b32 v149, v6 offset:3460
    ds_read_b32 v150, v6 offset:3488
    ds_read_b32 v151, v6 offset:3492
    ds_read_b32 v152, v6 offset:3520
    ds_read_b32 v153, v6 offset:3524
    ds_read_b32 v154, v6 offset:3552
    ds_read_b32 v155, v6 offset:3556
    ds_read_b32 v156, v6 offset:3584
    ds_read_b32 v157, v6 offset:3588
    s_waitcnt lgkmcnt(0)
    v_lshlrev_b32 v5, 4, v3
    v_add_u32 v5, s29, v5
    v_add_f32 v84, v84, v44
    v_add_f32 v85, v85, v45
    v_add_f32 v86, v86, v46
    v_add_f32 v87, v87, v47
    v_add_f32 v88, v88, v48
    v_add_f32 v89, v89, v49
    v_add_f32 v90, v90, v50
    v_add_f32 v91, v91, v51
    v_add_f32 v92, v92, v52
    v_add_f32 v93, v93, v53
    v_add_f32 v94, v94, v54
    v_add_f32 v95, v95, v55
    v_add_f32 v96, v96, v56
    v_add_f32 v97, v97, v57
    v_add_f32 v98, v98, v58
    v_add_f32 v99, v99, v59
    v_add_f32 v100, v100, v60
    v_add_f32 v101, v101, v61
    v_add_f32 v102, v102, v62
    v_add_f32 v103, v103, v63
    v_add_f32 v104, v104, v64
    v_add_f32 v105, v105, v65
    v_add_f32 v106, v106, v66
    v_add_f32 v107, v107, v67
    v_add_f32 v108, v108, v68
    v_add_f32 v109, v109, v69
    v_add_f32 v110, v110, v70
    v_add_f32 v111, v111, v71
    v_add_f32 v112, v112, v72
    v_add_f32 v113, v113, v73
    v_add_f32 v114, v114, v74
    v_add_f32 v115, v115, v75
    v_add_f32 v116, v116, v76
    v_add_f32 v117, v117, v77
    v_add_f32 v118, v118, v78
    v_add_f32 v119, v119, v79
    v_sub_f32 v80, 0, v80
    v_fmac_f32 v8, v80, v84
    v_fmac_f32 v9, v80, v85
    v_fmac_f32 v10, v80, v86
    v_fmac_f32 v11, v80, v87
    v_mul_f32 v8, v8, v81
    v_mul_f32 v9, v9, v81
    v_mul_f32 v10, v10, v81
    v_mul_f32 v11, v11, v81
    v_mul_f32 v44, 0x3fb8aa3b, v8
    v_mul_f32 v45, 0x3fb8aa3b, v9
    v_mul_f32 v46, 0x3fb8aa3b, v10
    v_mul_f32 v47, 0x3fb8aa3b, v11
    v_min_f32 v44, 0, v44
    v_min_f32 v45, 0, v45
    v_min_f32 v46, 0, v46
    v_min_f32 v47, 0, v47
    v_exp_f32 v44, v44
    v_exp_f32 v45, v45
    v_exp_f32 v46, v46
    v_exp_f32 v47, v47
    v_max_f32 v8, 0, v8
    v_max_f32 v9, 0, v9
    v_max_f32 v10, 0, v10
    v_max_f32 v11, 0, v11
    v_add_f32 v8, 0x358637bd, v8
    v_add_f32 v9, 0x358637bd, v9
    v_add_f32 v10, 0x358637bd, v10
    v_add_f32 v11, 0x358637bd, v11
    v_add_f32 v8, v8, v44
    v_add_f32 v9, v9, v45
    v_add_f32 v10, v10, v46
    v_add_f32 v11, v11, v47
    v_cvt_pk_bf16_f32 v8, v8, v9
    v_cvt_pk_bf16_f32 v9, v10, v11
    v_add_u32 v140, v140, v5
    v_add_u32 v141, v141, v5
    ds_write_b32 v140, v8
    ds_write_b32 v141, v9
    v_fmac_f32 v12, v80, v88
    v_fmac_f32 v13, v80, v89
    v_fmac_f32 v14, v80, v90
    v_fmac_f32 v15, v80, v91
    v_mul_f32 v12, v12, v81
    v_mul_f32 v13, v13, v81
    v_mul_f32 v14, v14, v81
    v_mul_f32 v15, v15, v81
    v_mul_f32 v44, 0x3fb8aa3b, v12
    v_mul_f32 v45, 0x3fb8aa3b, v13
    v_mul_f32 v46, 0x3fb8aa3b, v14
    v_mul_f32 v47, 0x3fb8aa3b, v15
    v_min_f32 v44, 0, v44
    v_min_f32 v45, 0, v45
    v_min_f32 v46, 0, v46
    v_min_f32 v47, 0, v47
    v_exp_f32 v44, v44
    v_exp_f32 v45, v45
    v_exp_f32 v46, v46
    v_exp_f32 v47, v47
    v_max_f32 v12, 0, v12
    v_max_f32 v13, 0, v13
    v_max_f32 v14, 0, v14
    v_max_f32 v15, 0, v15
    v_add_f32 v12, 0x358637bd, v12
    v_add_f32 v13, 0x358637bd, v13
    v_add_f32 v14, 0x358637bd, v14
    v_add_f32 v15, 0x358637bd, v15
    v_add_f32 v12, v12, v44
    v_add_f32 v13, v13, v45
    v_add_f32 v14, v14, v46
    v_add_f32 v15, v15, v47
    v_cvt_pk_bf16_f32 v12, v12, v13
    v_cvt_pk_bf16_f32 v13, v14, v15
    v_add_u32 v142, v142, v5
    v_add_u32 v143, v143, v5
    ds_write_b32 v142, v12
    ds_write_b32 v143, v13
    v_fmac_f32 v16, v80, v92
    v_fmac_f32 v17, v80, v93
    v_fmac_f32 v18, v80, v94
    v_fmac_f32 v19, v80, v95
    v_mul_f32 v16, v16, v81
    v_mul_f32 v17, v17, v81
    v_mul_f32 v18, v18, v81
    v_mul_f32 v19, v19, v81
    v_mul_f32 v44, 0x3fb8aa3b, v16
    v_mul_f32 v45, 0x3fb8aa3b, v17
    v_mul_f32 v46, 0x3fb8aa3b, v18
    v_mul_f32 v47, 0x3fb8aa3b, v19
    v_min_f32 v44, 0, v44
    v_min_f32 v45, 0, v45
    v_min_f32 v46, 0, v46
    v_min_f32 v47, 0, v47
    v_exp_f32 v44, v44
    v_exp_f32 v45, v45
    v_exp_f32 v46, v46
    v_exp_f32 v47, v47
    v_max_f32 v16, 0, v16
    v_max_f32 v17, 0, v17
    v_max_f32 v18, 0, v18
    v_max_f32 v19, 0, v19
    v_add_f32 v16, 0x358637bd, v16
    v_add_f32 v17, 0x358637bd, v17
    v_add_f32 v18, 0x358637bd, v18
    v_add_f32 v19, 0x358637bd, v19
    v_add_f32 v16, v16, v44
    v_add_f32 v17, v17, v45
    v_add_f32 v18, v18, v46
    v_add_f32 v19, v19, v47
    v_cvt_pk_bf16_f32 v16, v16, v17
    v_cvt_pk_bf16_f32 v17, v18, v19
    v_add_u32 v144, v144, v5
    v_add_u32 v145, v145, v5
    ds_write_b32 v144, v16
    ds_write_b32 v145, v17
    v_fmac_f32 v20, v80, v96
    v_fmac_f32 v21, v80, v97
    v_fmac_f32 v22, v80, v98
    v_fmac_f32 v23, v80, v99
    v_mul_f32 v20, v20, v81
    v_mul_f32 v21, v21, v81
    v_mul_f32 v22, v22, v81
    v_mul_f32 v23, v23, v81
    v_mul_f32 v44, 0x3fb8aa3b, v20
    v_mul_f32 v45, 0x3fb8aa3b, v21
    v_mul_f32 v46, 0x3fb8aa3b, v22
    v_mul_f32 v47, 0x3fb8aa3b, v23
    v_min_f32 v44, 0, v44
    v_min_f32 v45, 0, v45
    v_min_f32 v46, 0, v46
    v_min_f32 v47, 0, v47
    v_exp_f32 v44, v44
    v_exp_f32 v45, v45
    v_exp_f32 v46, v46
    v_exp_f32 v47, v47
    v_max_f32 v20, 0, v20
    v_max_f32 v21, 0, v21
    v_max_f32 v22, 0, v22
    v_max_f32 v23, 0, v23
    v_add_f32 v20, 0x358637bd, v20
    v_add_f32 v21, 0x358637bd, v21
    v_add_f32 v22, 0x358637bd, v22
    v_add_f32 v23, 0x358637bd, v23
    v_add_f32 v20, v20, v44
    v_add_f32 v21, v21, v45
    v_add_f32 v22, v22, v46
    v_add_f32 v23, v23, v47
    v_cvt_pk_bf16_f32 v20, v20, v21
    v_cvt_pk_bf16_f32 v21, v22, v23
    v_add_u32 v146, v146, v5
    v_add_u32 v147, v147, v5
    ds_write_b32 v146, v20
    ds_write_b32 v147, v21
    v_fmac_f32 v24, v80, v100
    v_fmac_f32 v25, v80, v101
    v_fmac_f32 v26, v80, v102
    v_fmac_f32 v27, v80, v103
    v_mul_f32 v24, v24, v81
    v_mul_f32 v25, v25, v81
    v_mul_f32 v26, v26, v81
    v_mul_f32 v27, v27, v81
    v_mul_f32 v44, 0x3fb8aa3b, v24
    v_mul_f32 v45, 0x3fb8aa3b, v25
    v_mul_f32 v46, 0x3fb8aa3b, v26
    v_mul_f32 v47, 0x3fb8aa3b, v27
    v_min_f32 v44, 0, v44
    v_min_f32 v45, 0, v45
    v_min_f32 v46, 0, v46
    v_min_f32 v47, 0, v47
    v_exp_f32 v44, v44
    v_exp_f32 v45, v45
    v_exp_f32 v46, v46
    v_exp_f32 v47, v47
    v_max_f32 v24, 0, v24
    v_max_f32 v25, 0, v25
    v_max_f32 v26, 0, v26
    v_max_f32 v27, 0, v27
    v_add_f32 v24, 0x358637bd, v24
    v_add_f32 v25, 0x358637bd, v25
    v_add_f32 v26, 0x358637bd, v26
    v_add_f32 v27, 0x358637bd, v27
    v_add_f32 v24, v24, v44
    v_add_f32 v25, v25, v45
    v_add_f32 v26, v26, v46
    v_add_f32 v27, v27, v47
    v_cvt_pk_bf16_f32 v24, v24, v25
    v_cvt_pk_bf16_f32 v25, v26, v27
    v_add_u32 v148, v148, v5
    v_add_u32 v149, v149, v5
    ds_write_b32 v148, v24
    ds_write_b32 v149, v25
    v_fmac_f32 v28, v80, v104
    v_fmac_f32 v29, v80, v105
    v_fmac_f32 v30, v80, v106
    v_fmac_f32 v31, v80, v107
    v_mul_f32 v28, v28, v81
    v_mul_f32 v29, v29, v81
    v_mul_f32 v30, v30, v81
    v_mul_f32 v31, v31, v81
    v_mul_f32 v44, 0x3fb8aa3b, v28
    v_mul_f32 v45, 0x3fb8aa3b, v29
    v_mul_f32 v46, 0x3fb8aa3b, v30
    v_mul_f32 v47, 0x3fb8aa3b, v31
    v_min_f32 v44, 0, v44
    v_min_f32 v45, 0, v45
    v_min_f32 v46, 0, v46
    v_min_f32 v47, 0, v47
    v_exp_f32 v44, v44
    v_exp_f32 v45, v45
    v_exp_f32 v46, v46
    v_exp_f32 v47, v47
    v_max_f32 v28, 0, v28
    v_max_f32 v29, 0, v29
    v_max_f32 v30, 0, v30
    v_max_f32 v31, 0, v31
    v_add_f32 v28, 0x358637bd, v28
    v_add_f32 v29, 0x358637bd, v29
    v_add_f32 v30, 0x358637bd, v30
    v_add_f32 v31, 0x358637bd, v31
    v_add_f32 v28, v28, v44
    v_add_f32 v29, v29, v45
    v_add_f32 v30, v30, v46
    v_add_f32 v31, v31, v47
    v_cvt_pk_bf16_f32 v28, v28, v29
    v_cvt_pk_bf16_f32 v29, v30, v31
    v_add_u32 v150, v150, v5
    v_add_u32 v151, v151, v5
    ds_write_b32 v150, v28
    ds_write_b32 v151, v29
    v_fmac_f32 v32, v80, v108
    v_fmac_f32 v33, v80, v109
    v_fmac_f32 v34, v80, v110
    v_fmac_f32 v35, v80, v111
    v_mul_f32 v32, v32, v81
    v_mul_f32 v33, v33, v81
    v_mul_f32 v34, v34, v81
    v_mul_f32 v35, v35, v81
    v_mul_f32 v44, 0x3fb8aa3b, v32
    v_mul_f32 v45, 0x3fb8aa3b, v33
    v_mul_f32 v46, 0x3fb8aa3b, v34
    v_mul_f32 v47, 0x3fb8aa3b, v35
    v_min_f32 v44, 0, v44
    v_min_f32 v45, 0, v45
    v_min_f32 v46, 0, v46
    v_min_f32 v47, 0, v47
    v_exp_f32 v44, v44
    v_exp_f32 v45, v45
    v_exp_f32 v46, v46
    v_exp_f32 v47, v47
    v_max_f32 v32, 0, v32
    v_max_f32 v33, 0, v33
    v_max_f32 v34, 0, v34
    v_max_f32 v35, 0, v35
    v_add_f32 v32, 0x358637bd, v32
    v_add_f32 v33, 0x358637bd, v33
    v_add_f32 v34, 0x358637bd, v34
    v_add_f32 v35, 0x358637bd, v35
    v_add_f32 v32, v32, v44
    v_add_f32 v33, v33, v45
    v_add_f32 v34, v34, v46
    v_add_f32 v35, v35, v47
    v_cvt_pk_bf16_f32 v32, v32, v33
    v_cvt_pk_bf16_f32 v33, v34, v35
    v_add_u32 v152, v152, v5
    v_add_u32 v153, v153, v5
    ds_write_b32 v152, v32
    ds_write_b32 v153, v33
    v_fmac_f32 v36, v80, v112
    v_fmac_f32 v37, v80, v113
    v_fmac_f32 v38, v80, v114
    v_fmac_f32 v39, v80, v115
    v_mul_f32 v36, v36, v81
    v_mul_f32 v37, v37, v81
    v_mul_f32 v38, v38, v81
    v_mul_f32 v39, v39, v81
    v_mul_f32 v44, 0x3fb8aa3b, v36
    v_mul_f32 v45, 0x3fb8aa3b, v37
    v_mul_f32 v46, 0x3fb8aa3b, v38
    v_mul_f32 v47, 0x3fb8aa3b, v39
    v_min_f32 v44, 0, v44
    v_min_f32 v45, 0, v45
    v_min_f32 v46, 0, v46
    v_min_f32 v47, 0, v47
    v_exp_f32 v44, v44
    v_exp_f32 v45, v45
    v_exp_f32 v46, v46
    v_exp_f32 v47, v47
    v_max_f32 v36, 0, v36
    v_max_f32 v37, 0, v37
    v_max_f32 v38, 0, v38
    v_max_f32 v39, 0, v39
    v_add_f32 v36, 0x358637bd, v36
    v_add_f32 v37, 0x358637bd, v37
    v_add_f32 v38, 0x358637bd, v38
    v_add_f32 v39, 0x358637bd, v39
    v_add_f32 v36, v36, v44
    v_add_f32 v37, v37, v45
    v_add_f32 v38, v38, v46
    v_add_f32 v39, v39, v47
    v_cvt_pk_bf16_f32 v36, v36, v37
    v_cvt_pk_bf16_f32 v37, v38, v39
    v_add_u32 v154, v154, v5
    v_add_u32 v155, v155, v5
    ds_write_b32 v154, v36
    ds_write_b32 v155, v37
    v_fmac_f32 v40, v80, v116
    v_fmac_f32 v41, v80, v117
    v_fmac_f32 v42, v80, v118
    v_fmac_f32 v43, v80, v119
    v_mul_f32 v40, v40, v81
    v_mul_f32 v41, v41, v81
    v_mul_f32 v42, v42, v81
    v_mul_f32 v43, v43, v81
    v_mul_f32 v44, 0x3fb8aa3b, v40
    v_mul_f32 v45, 0x3fb8aa3b, v41
    v_mul_f32 v46, 0x3fb8aa3b, v42
    v_mul_f32 v47, 0x3fb8aa3b, v43
    v_min_f32 v44, 0, v44
    v_min_f32 v45, 0, v45
    v_min_f32 v46, 0, v46
    v_min_f32 v47, 0, v47
    v_exp_f32 v44, v44
    v_exp_f32 v45, v45
    v_exp_f32 v46, v46
    v_exp_f32 v47, v47
    v_max_f32 v40, 0, v40
    v_max_f32 v41, 0, v41
    v_max_f32 v42, 0, v42
    v_max_f32 v43, 0, v43
    v_add_f32 v40, 0x358637bd, v40
    v_add_f32 v41, 0x358637bd, v41
    v_add_f32 v42, 0x358637bd, v42
    v_add_f32 v43, 0x358637bd, v43
    v_add_f32 v40, v40, v44
    v_add_f32 v41, v41, v45
    v_add_f32 v42, v42, v46
    v_add_f32 v43, v43, v47
    v_cvt_pk_bf16_f32 v40, v40, v41
    v_cvt_pk_bf16_f32 v41, v42, v43
    v_add_u32 v156, v156, v5
    v_add_u32 v157, v157, v5
    ds_write_b32 v156, v40
    ds_write_b32 v157, v41
    s_waitcnt lgkmcnt(0)
    ds_read_b128 v[84:87], v7 offset:0
    ds_read_b128 v[88:91], v7 offset:1024
    ds_read_b128 v[92:95], v7 offset:2048
    ds_read_b128 v[96:99], v7 offset:3072
    ds_read_b128 v[100:103], v7 offset:4096
    ds_read_b128 v[104:107], v7 offset:5120
    s_add_u32 s8, s4, 0x25c0000
    s_addc_u32 s9, s5, 0
    s_mov_b32 s10, 0x300000
    s_mov_b32 s11, 0x20000
    s_lshl_b32 s28, s20, 3
    s_add_u32 s28, s28, s26
    s_lshl_b32 s30, s28, 5
    s_lshl_b32 s31, s21, 3
    s_add_u32 s30, s30, s31
    s_mul_i32 s30, s30, 768
    s_waitcnt lgkmcnt(0)
    buffer_store_dwordx4 v[84:87], v2, s[8:11], s30 offen offset:0 sc1
    buffer_store_dwordx4 v[88:91], v2, s[8:11], s30 offen offset:1024 sc1
    buffer_store_dwordx4 v[92:95], v2, s[8:11], s30 offen offset:2048 sc1
    buffer_store_dwordx4 v[96:99], v2, s[8:11], s30 offen offset:3072 sc1
    s_add_u32 s30, s30, 4096
    buffer_store_dwordx4 v[100:103], v2, s[8:11], s30 offen offset:0 sc1
    buffer_store_dwordx4 v[104:107], v2, s[8:11], s30 offen offset:1024 sc1
    s_cmp_lg_u32 s21, 0
    s_cbranch_scc1 mega_A6_cend
    s_add_u32 s8, s4, 0x28d0000
    s_addc_u32 s9, s5, 0
    s_mov_b32 s10, 0x2000
    s_mov_b32 s11, 0x20000
    s_lshl_b32 s28, s28, 4
    v_add_u32 v5, s28, v3
    v_lshlrev_b32 v5, 2, v5
    v_sub_f32 v80, 0, v80
    s_mov_b32 exec_lo, 0xffff
    s_mov_b32 exec_hi, 0x0
    buffer_store_dword v80, v5, s[8:11], 0 offen sc1
    s_mov_b64 exec, -1
    s_branch mega_A6_cend
mega_A6_kvepi:
    s_lshl_b32 s28, s26, 7
    s_add_u32 s28, s28, 139264
    v_lshl_add_u32 v5, v4, 5, s28
    ds_read_b128 v[80:83], v5
    ds_read_b128 v[84:87], v5 offset:16
    ds_read_b128 v[88:91], v5 offset:1024
    ds_read_b128 v[92:95], v5 offset:1040
    v_lshlrev_b32 v6, 2, v3
    v_add_u32 v6, 139264, v6
    ds_read_b32 v96, v6 offset:2048
    ds_read_b32 v105, v6 offset:2688
    ds_read_b32 v97, v6 offset:2112
    ds_read_b32 v106, v6 offset:2752
    ds_read_b32 v98, v6 offset:2176
    ds_read_b32 v107, v6 offset:2816
    ds_read_b32 v99, v6 offset:2240
    ds_read_b32 v108, v6 offset:2880
    ds_read_b32 v100, v6 offset:2304
    ds_read_b32 v109, v6 offset:2944
    ds_read_b32 v101, v6 offset:2368
    ds_read_b32 v110, v6 offset:3008
    ds_read_b32 v102, v6 offset:2432
    ds_read_b32 v111, v6 offset:3072
    ds_read_b32 v103, v6 offset:2496
    ds_read_b32 v112, v6 offset:3136
    ds_read_b32 v104, v6 offset:2560
    ds_read_b32 v113, v6 offset:3200
    s_waitcnt lgkmcnt(0)
    v_add_f32 v8, v8, v44
    v_add_f32 v9, v9, v45
    v_add_f32 v10, v10, v46
    v_add_f32 v11, v11, v47
    v_add_f32 v12, v12, v48
    v_add_f32 v13, v13, v49
    v_add_f32 v14, v14, v50
    v_add_f32 v15, v15, v51
    v_add_f32 v16, v16, v52
    v_add_f32 v17, v17, v53
    v_add_f32 v18, v18, v54
    v_add_f32 v19, v19, v55
    v_add_f32 v20, v20, v56
    v_add_f32 v21, v21, v57
    v_add_f32 v22, v22, v58
    v_add_f32 v23, v23, v59
    v_add_f32 v24, v24, v60
    v_add_f32 v25, v25, v61
    v_add_f32 v26, v26, v62
    v_add_f32 v27, v27, v63
    v_add_f32 v28, v28, v64
    v_add_f32 v29, v29, v65
    v_add_f32 v30, v30, v66
    v_add_f32 v31, v31, v67
    v_add_f32 v32, v32, v68
    v_add_f32 v33, v33, v69
    v_add_f32 v34, v34, v70
    v_add_f32 v35, v35, v71
    v_add_f32 v36, v36, v72
    v_add_f32 v37, v37, v73
    v_add_f32 v38, v38, v74
    v_add_f32 v39, v39, v75
    v_add_f32 v40, v40, v76
    v_add_f32 v41, v41, v77
    v_add_f32 v42, v42, v78
    v_add_f32 v43, v43, v79
    v_add_f32 v96, v96, v105
    v_add_f32 v97, v97, v106
    v_add_f32 v98, v98, v107
    v_add_f32 v99, v99, v108
    v_add_f32 v100, v100, v109
    v_add_f32 v101, v101, v110
    v_add_f32 v102, v102, v111
    v_add_f32 v103, v103, v112
    v_add_f32 v104, v104, v113
    v_add_f32 v80, v80, v88
    v_add_f32 v81, v81, v89
    v_mul_f32 v80, 0x3ae38e39, v80
    v_mul_f32 v81, 0x3ae38e39, v81
    v_fma_f32 v81, -v80, v80, v81
    v_max_f32 v81, 0, v81
    v_add_f32 v81, 0x3727c5ac, v81
    v_rsq_f32 v81, v81
    s_nop 0
    v_add_f32 v82, v82, v90
    v_add_f32 v83, v83, v91
    v_mul_f32 v82, 0x3ae38e39, v82
    v_mul_f32 v83, 0x3ae38e39, v83
    v_fma_f32 v83, -v82, v82, v83
    v_max_f32 v83, 0, v83
    v_add_f32 v83, 0x3727c5ac, v83
    v_rsq_f32 v83, v83
    s_nop 0
    v_add_f32 v84, v84, v92
    v_add_f32 v85, v85, v93
    v_mul_f32 v84, 0x3ae38e39, v84
    v_mul_f32 v85, 0x3ae38e39, v85
    v_fma_f32 v85, -v84, v84, v85
    v_max_f32 v85, 0, v85
    v_add_f32 v85, 0x3727c5ac, v85
    v_rsq_f32 v85, v85
    s_nop 0
    v_add_f32 v86, v86, v94
    v_add_f32 v87, v87, v95
    v_mul_f32 v86, 0x3ae38e39, v86
    v_mul_f32 v87, 0x3ae38e39, v87
    v_fma_f32 v87, -v86, v86, v87
    v_max_f32 v87, 0, v87
    v_add_f32 v87, 0x3727c5ac, v87
    v_rsq_f32 v87, v87
    s_nop 0
    v_cmp_gt_u32 vcc, 8, v3
    s_mov_b64 s[34:35], vcc
    v_sub_f32 v44, 0, v96
    v_fmac_f32 v8, v44, v80
    v_fmac_f32 v9, v44, v82
    v_fmac_f32 v10, v44, v84
    v_fmac_f32 v11, v44, v86
    v_mul_f32 v8, v8, v81
    v_mul_f32 v9, v9, v83
    v_mul_f32 v10, v10, v85
    v_mul_f32 v11, v11, v87
    v_mul_f32 v44, 0x3fb8aa3b, v8
    v_mul_f32 v45, 0x3fb8aa3b, v9
    v_mul_f32 v46, 0x3fb8aa3b, v10
    v_mul_f32 v47, 0x3fb8aa3b, v11
    v_min_f32 v44, 0, v44
    v_min_f32 v45, 0, v45
    v_min_f32 v46, 0, v46
    v_min_f32 v47, 0, v47
    v_exp_f32 v44, v44
    v_exp_f32 v45, v45
    v_exp_f32 v46, v46
    v_exp_f32 v47, v47
    v_max_f32 v8, 0, v8
    v_max_f32 v9, 0, v9
    v_max_f32 v10, 0, v10
    v_max_f32 v11, 0, v11
    v_add_f32 v8, 0x358637bd, v8
    v_add_f32 v9, 0x358637bd, v9
    v_add_f32 v10, 0x358637bd, v10
    v_add_f32 v11, 0x358637bd, v11
    v_add_f32 v8, v8, v44
    v_add_f32 v9, v9, v45
    v_add_f32 v10, v10, v46
    v_add_f32 v11, v11, v47
    v_cvt_pk_bf16_f32 v8, v8, v9
    v_cvt_pk_bf16_f32 v9, v10, v11
    v_mov_b32 v10, 0
    v_mov_b32 v11, 0
    v_sub_f32 v44, 0, v97
    v_fmac_f32 v12, v44, v80
    v_fmac_f32 v13, v44, v82
    v_fmac_f32 v14, v44, v84
    v_fmac_f32 v15, v44, v86
    v_mul_f32 v12, v12, v81
    v_mul_f32 v13, v13, v83
    v_mul_f32 v14, v14, v85
    v_mul_f32 v15, v15, v87
    v_mul_f32 v44, 0x3fb8aa3b, v12
    v_mul_f32 v45, 0x3fb8aa3b, v13
    v_mul_f32 v46, 0x3fb8aa3b, v14
    v_mul_f32 v47, 0x3fb8aa3b, v15
    v_min_f32 v44, 0, v44
    v_min_f32 v45, 0, v45
    v_min_f32 v46, 0, v46
    v_min_f32 v47, 0, v47
    v_exp_f32 v44, v44
    v_exp_f32 v45, v45
    v_exp_f32 v46, v46
    v_exp_f32 v47, v47
    v_max_f32 v12, 0, v12
    v_max_f32 v13, 0, v13
    v_max_f32 v14, 0, v14
    v_max_f32 v15, 0, v15
    v_add_f32 v12, 0x358637bd, v12
    v_add_f32 v13, 0x358637bd, v13
    v_add_f32 v14, 0x358637bd, v14
    v_add_f32 v15, 0x358637bd, v15
    v_add_f32 v12, v12, v44
    v_add_f32 v13, v13, v45
    v_add_f32 v14, v14, v46
    v_add_f32 v15, v15, v47
    v_cvt_pk_bf16_f32 v12, v12, v13
    v_cvt_pk_bf16_f32 v13, v14, v15
    v_mov_b32 v14, 0
    v_mov_b32 v15, 0
    v_sub_f32 v44, 0, v98
    v_fmac_f32 v16, v44, v80
    v_fmac_f32 v17, v44, v82
    v_fmac_f32 v18, v44, v84
    v_fmac_f32 v19, v44, v86
    v_mul_f32 v16, v16, v81
    v_mul_f32 v17, v17, v83
    v_mul_f32 v18, v18, v85
    v_mul_f32 v19, v19, v87
    v_mul_f32 v44, 0x3fb8aa3b, v16
    v_mul_f32 v45, 0x3fb8aa3b, v17
    v_mul_f32 v46, 0x3fb8aa3b, v18
    v_mul_f32 v47, 0x3fb8aa3b, v19
    v_min_f32 v44, 0, v44
    v_min_f32 v45, 0, v45
    v_min_f32 v46, 0, v46
    v_min_f32 v47, 0, v47
    v_exp_f32 v44, v44
    v_exp_f32 v45, v45
    v_exp_f32 v46, v46
    v_exp_f32 v47, v47
    v_max_f32 v16, 0, v16
    v_max_f32 v17, 0, v17
    v_max_f32 v18, 0, v18
    v_max_f32 v19, 0, v19
    v_add_f32 v16, 0x358637bd, v16
    v_add_f32 v17, 0x358637bd, v17
    v_add_f32 v18, 0x358637bd, v18
    v_add_f32 v19, 0x358637bd, v19
    v_add_f32 v16, v16, v44
    v_add_f32 v17, v17, v45
    v_add_f32 v18, v18, v46
    v_add_f32 v19, v19, v47
    v_cvt_pk_bf16_f32 v16, v16, v17
    v_cvt_pk_bf16_f32 v17, v18, v19
    v_mov_b32 v18, 0
    v_mov_b32 v19, 0
    v_sub_f32 v44, 0, v99
    v_fmac_f32 v20, v44, v80
    v_fmac_f32 v21, v44, v82
    v_fmac_f32 v22, v44, v84
    v_fmac_f32 v23, v44, v86
    v_mul_f32 v20, v20, v81
    v_mul_f32 v21, v21, v83
    v_mul_f32 v22, v22, v85
    v_mul_f32 v23, v23, v87
    v_mul_f32 v44, 0x3fb8aa3b, v20
    v_mul_f32 v45, 0x3fb8aa3b, v21
    v_mul_f32 v46, 0x3fb8aa3b, v22
    v_mul_f32 v47, 0x3fb8aa3b, v23
    v_min_f32 v44, 0, v44
    v_min_f32 v45, 0, v45
    v_min_f32 v46, 0, v46
    v_min_f32 v47, 0, v47
    v_exp_f32 v44, v44
    v_exp_f32 v45, v45
    v_exp_f32 v46, v46
    v_exp_f32 v47, v47
    v_max_f32 v20, 0, v20
    v_max_f32 v21, 0, v21
    v_max_f32 v22, 0, v22
    v_max_f32 v23, 0, v23
    v_add_f32 v20, 0x358637bd, v20
    v_add_f32 v21, 0x358637bd, v21
    v_add_f32 v22, 0x358637bd, v22
    v_add_f32 v23, 0x358637bd, v23
    v_add_f32 v20, v20, v44
    v_add_f32 v21, v21, v45
    v_add_f32 v22, v22, v46
    v_add_f32 v23, v23, v47
    v_cvt_pk_bf16_f32 v20, v20, v21
    v_cvt_pk_bf16_f32 v21, v22, v23
    v_mov_b32 v22, 0
    v_mov_b32 v23, 0
    v_sub_f32 v44, 0, v100
    v_fmac_f32 v24, v44, v80
    v_fmac_f32 v25, v44, v82
    v_fmac_f32 v26, v44, v84
    v_fmac_f32 v27, v44, v86
    v_mul_f32 v24, v24, v81
    v_mul_f32 v25, v25, v83
    v_mul_f32 v26, v26, v85
    v_mul_f32 v27, v27, v87
    v_mul_f32 v44, 0x3fb8aa3b, v24
    v_mul_f32 v45, 0x3fb8aa3b, v25
    v_mul_f32 v46, 0x3fb8aa3b, v26
    v_mul_f32 v47, 0x3fb8aa3b, v27
    v_min_f32 v44, 0, v44
    v_min_f32 v45, 0, v45
    v_min_f32 v46, 0, v46
    v_min_f32 v47, 0, v47
    v_exp_f32 v44, v44
    v_exp_f32 v45, v45
    v_exp_f32 v46, v46
    v_exp_f32 v47, v47
    v_max_f32 v48, 0, v24
    v_max_f32 v49, 0, v25
    v_max_f32 v50, 0, v26
    v_max_f32 v51, 0, v27
    v_add_f32 v48, 0x358637bd, v48
    v_add_f32 v49, 0x358637bd, v49
    v_add_f32 v50, 0x358637bd, v50
    v_add_f32 v51, 0x358637bd, v51
    v_add_f32 v48, v48, v44
    v_add_f32 v49, v49, v45
    v_add_f32 v50, v50, v46
    v_add_f32 v51, v51, v47
    v_cndmask_b32 v24, v24, v48, s[34:35]
    v_cndmask_b32 v25, v25, v49, s[34:35]
    v_cndmask_b32 v26, v26, v50, s[34:35]
    v_cndmask_b32 v27, v27, v51, s[34:35]
    v_cvt_pk_bf16_f32 v24, v24, v25
    v_cvt_pk_bf16_f32 v25, v26, v27
    v_mov_b32 v26, 0
    v_mov_b32 v27, 0
    v_sub_f32 v44, 0, v101
    v_fmac_f32 v28, v44, v80
    v_fmac_f32 v29, v44, v82
    v_fmac_f32 v30, v44, v84
    v_fmac_f32 v31, v44, v86
    v_mul_f32 v28, v28, v81
    v_mul_f32 v29, v29, v83
    v_mul_f32 v30, v30, v85
    v_mul_f32 v31, v31, v87
    v_cvt_pk_bf16_f32 v28, v28, v29
    v_cvt_pk_bf16_f32 v29, v30, v31
    v_mov_b32 v30, 0
    v_mov_b32 v31, 0
    v_sub_f32 v44, 0, v102
    v_fmac_f32 v32, v44, v80
    v_fmac_f32 v33, v44, v82
    v_fmac_f32 v34, v44, v84
    v_fmac_f32 v35, v44, v86
    v_mul_f32 v32, v32, v81
    v_mul_f32 v33, v33, v83
    v_mul_f32 v34, v34, v85
    v_mul_f32 v35, v35, v87
    v_cvt_pk_bf16_f32 v32, v32, v33
    v_cvt_pk_bf16_f32 v33, v34, v35
    v_mov_b32 v34, 0
    v_mov_b32 v35, 0
    v_sub_f32 v44, 0, v103
    v_fmac_f32 v36, v44, v80
    v_fmac_f32 v37, v44, v82
    v_fmac_f32 v38, v44, v84
    v_fmac_f32 v39, v44, v86
    v_mul_f32 v36, v36, v81
    v_mul_f32 v37, v37, v83
    v_mul_f32 v38, v38, v85
    v_mul_f32 v39, v39, v87
    v_cvt_pk_bf16_f32 v36, v36, v37
    v_cvt_pk_bf16_f32 v37, v38, v39
    v_mov_b32 v38, 0
    v_mov_b32 v39, 0
    v_sub_f32 v44, 0, v104
    v_fmac_f32 v40, v44, v80
    v_fmac_f32 v41, v44, v82
    v_fmac_f32 v42, v44, v84
    v_fmac_f32 v43, v44, v86
    v_mul_f32 v40, v40, v81
    v_mul_f32 v41, v41, v83
    v_mul_f32 v42, v42, v85
    v_mul_f32 v43, v43, v87
    v_cvt_pk_bf16_f32 v40, v40, v41
    v_cvt_pk_bf16_f32 v41, v42, v43
    v_mov_b32 v42, 0
    v_mov_b32 v43, 0
    v_mov_b32 v150, 0x3f803f80
    v_cndmask_b32 v148, v24, v150, s[34:35]
    v_cndmask_b32 v149, v25, v150, s[34:35]
    v_mov_b32 v150, 0
    v_mov_b32 v151, 0
    s_nop 1
    v_mfma_f32_16x16x32_bf16 v[84:87], v[148:151], v[8:11], 0
    v_mfma_f32_16x16x32_bf16 v[88:91], v[28:31], v[8:11], 0
    v_mfma_f32_16x16x32_bf16 v[92:95], v[148:151], v[12:15], 0
    v_mfma_f32_16x16x32_bf16 v[96:99], v[28:31], v[12:15], 0
    v_mfma_f32_16x16x32_bf16 v[100:103], v[32:35], v[12:15], 0
    v_mfma_f32_16x16x32_bf16 v[104:107], v[28:31], v[16:19], 0
    v_mfma_f32_16x16x32_bf16 v[108:111], v[32:35], v[16:19], 0
    v_mfma_f32_16x16x32_bf16 v[112:115], v[36:39], v[16:19], 0
    v_mfma_f32_16x16x32_bf16 v[116:119], v[32:35], v[20:23], 0
    v_mfma_f32_16x16x32_bf16 v[120:123], v[36:39], v[20:23], 0
    v_mfma_f32_16x16x32_bf16 v[124:127], v[40:43], v[20:23], 0
    v_mfma_f32_16x16x32_bf16 v[128:131], v[36:39], v[24:27], 0
    v_mfma_f32_16x16x32_bf16 v[132:135], v[40:43], v[24:27], 0
    v_mfma_f32_16x16x32_bf16 v[136:139], v[148:151], v[16:19], 0
    v_mfma_f32_16x16x32_bf16 v[140:143], v[148:151], v[20:23], 0
    v_mfma_f32_16x16x32_bf16 v[144:147], v[148:151], v[24:27], 0
    s_barrier
    s_lshl_b32 s29, s22, 14
    v_add_u32 v5, s29, v2
    s_nop 7
    ds_write_b128 v5, v[84:87] offset:1024
    ds_write_b128 v5, v[88:91] offset:2048
    ds_write_b128 v5, v[92:95] offset:3072
    ds_write_b128 v5, v[96:99] offset:4096
    ds_write_b128 v5, v[100:103] offset:5120
    ds_write_b128 v5, v[104:107] offset:6144
    ds_write_b128 v5, v[108:111] offset:7168
    ds_write_b128 v5, v[112:115] offset:8192
    ds_write_b128 v5, v[116:119] offset:9216
    ds_write_b128 v5, v[120:123] offset:10240
    ds_write_b128 v5, v[124:127] offset:11264
    ds_write_b128 v5, v[128:131] offset:12288
    ds_write_b128 v5, v[132:135] offset:13312
    ds_write_b128 v5, v[136:139] offset:14336
    ds_write_b128 v5, v[140:143] offset:15360
    ds_write_b128 v5, v[144:147] offset:0
    s_waitcnt lgkmcnt(0)
mega_A6_cend:
    s_branch mega_A6_join
mega_A6_load:
    s_sub_u32 s24, s22, 8
    s_cmp_ge_u32 s24, 2
    s_cbranch_scc1 mega_A6_wload
    s_mov_b32 s8, s60
    s_mov_b32 s9, s61
    s_mov_b32 s10, 0x240000
    s_mov_b32 s11, 0x20000
    v_lshrrev_b32 v5, 3, v1
    v_mul_u32_u24 v5, 1152, v5
    v_and_b32 v6, 7, v1
    v_xor_b32 v7, v6, v4
    v_lshl_add_u32 v8, v7, 4, v5
    v_or_b32 v7, 4, v4
    v_xor_b32 v7, v6, v7
    v_lshl_add_u32 v9, v7, 4, v5
    s_lshl_b32 s26, s20, 7
    s_lshl_b32 s27, s24, 6
    s_add_u32 s26, s26, s27
    s_mul_i32 s26, s26, 1152
    s_lshl_b32 s27, s24, 13
    s_add_u32 s30, s27, 0
    s_add_u32 s31, s26, 0
    s_add_u32 m0, s30, 0
    s_add_u32 s32, s31, 0
    buffer_load_dwordx4 v8, s[8:11], s32 offen lds
    s_add_u32 m0, s30, 1024
    s_add_u32 s32, s31, 9216
    buffer_load_dwordx4 v9, s[8:11], s32 offen lds
    s_add_u32 m0, s30, 2048
    s_add_u32 s32, s31, 18432
    buffer_load_dwordx4 v8, s[8:11], s32 offen lds
    s_add_u32 m0, s30, 3072
    s_add_u32 s32, s31, 27648
    buffer_load_dwordx4 v9, s[8:11], s32 offen lds
    s_add_u32 m0, s30, 4096
    s_add_u32 s32, s31, 36864
    buffer_load_dwordx4 v8, s[8:11], s32 offen lds
    s_add_u32 m0, s30, 5120
    s_add_u32 s32, s31, 46080
    buffer_load_dwordx4 v9, s[8:11], s32 offen lds
    s_add_u32 m0, s30, 6144
    s_add_u32 s32, s31, 55296
    buffer_load_dwordx4 v8, s[8:11], s32 offen lds
    s_add_u32 m0, s30, 7168
    s_add_u32 s32, s31, 64512
    buffer_load_dwordx4 v9, s[8:11], s32 offen lds
    s_add_u32 s30, s27, 34816
    s_add_u32 s31, s26, 128
    s_add_u32 m0, s30, 0
    s_add_u32 s32, s31, 0
    buffer_load_dwordx4 v8, s[8:11], s32 offen lds
    s_add_u32 m0, s30, 1024
    s_add_u32 s32, s31, 9216
    buffer_load_dwordx4 v9, s[8:11], s32 offen lds
    s_add_u32 m0, s30, 2048
    s_add_u32 s32, s31, 18432
    buffer_load_dwordx4 v8, s[8:11], s32 offen lds
    s_add_u32 m0, s30, 3072
    s_add_u32 s32, s31, 27648
    buffer_load_dwordx4 v9, s[8:11], s32 offen lds
    s_add_u32 m0, s30, 4096
    s_add_u32 s32, s31, 36864
    buffer_load_dwordx4 v8, s[8:11], s32 offen lds
    s_add_u32 m0, s30, 5120
    s_add_u32 s32, s31, 46080
    buffer_load_dwordx4 v9, s[8:11], s32 offen lds
    s_add_u32 m0, s30, 6144
    s_add_u32 s32, s31, 55296
    buffer_load_dwordx4 v8, s[8:11], s32 offen lds
    s_add_u32 m0, s30, 7168
    s_add_u32 s32, s31, 64512
    buffer_load_dwordx4 v9, s[8:11], s32 offen lds
    v_bfe_u32 v5, v3, 1, 3
    v_xor_b32 v10, v4, v5
    v_lshlrev_b32 v10, 4, v10
    v_lshl_add_u32 v10, v3, 7, v10
    v_or_b32 v11, 4, v4
    v_xor_b32 v11, v11, v5
    v_lshlrev_b32 v11, 4, v11
    v_lshl_add_u32 v11, v3, 7, v11
    v_add_u32 v10, s27, v10
    v_add_u32 v11, s27, v11
    v_mov_b32 v16, 0
    v_mov_b32 v17, 0
    v_mov_b32 v18, 0
    v_mov_b32 v19, 0
    v_mov_b32 v20, 0
    v_mov_b32 v21, 0
    v_mov_b32 v22, 0
    v_mov_b32 v23, 0
    v_mov_b32 v24, 0
    v_mov_b32 v25, 0
    v_mov_b32 v26, 0
    v_mov_b32 v27, 0
    v_mov_b32 v28, 0
    v_mov_b32 v29, 0
    v_mov_b32 v30, 0
    v_mov_b32 v31, 0
    v_mov_b32 v32, 0
    v_mov_b32 v33, 0
    v_mov_b32 v34, 0
    v_mov_b32 v35, 0
    v_mov_b32 v36, 0
    v_mov_b32 v37, 0
    v_mov_b32 v38, 0
    v_mov_b32 v39, 0
    v_mov_b32 v40, 0
    v_mov_b32 v41, 0
    v_mov_b32 v42, 0
    v_mov_b32 v43, 0
    v_mov_b32 v44, 0
    v_mov_b32 v45, 0
    v_mov_b32 v46, 0
    v_mov_b32 v47, 0
    v_mov_b32 v80, 0x3f803f80
    v_mov_b32 v81, 0x3f803f80
    v_mov_b32 v82, 0x3f803f80
    v_mov_b32 v83, 0x3f803f80
    s_mov_b32 s28, 0
mega_A6_xl:
    s_cmp_le_u32 s28, 7
    s_cbranch_scc1 mega_A6_xb
    s_waitcnt vmcnt(0)
    s_branch mega_A6_xwd
mega_A6_xb:
    s_waitcnt vmcnt(8)
mega_A6_xwd:
    s_barrier
    s_cmp_gt_u32 s28, 6
    s_cbranch_scc1 mega_A6_xni
    s_add_u32 s29, s28, 2
    s_and_b32 s30, s29, 3
    s_mul_i32 s30, s30, 34816
    s_add_u32 s30, s30, s27
    s_lshl_b32 s31, s29, 7
    s_add_u32 s31, s31, s26
    s_add_u32 m0, s30, 0
    s_add_u32 s32, s31, 0
    buffer_load_dwordx4 v8, s[8:11], s32 offen lds
    s_add_u32 m0, s30, 1024
    s_add_u32 s32, s31, 9216
    buffer_load_dwordx4 v9, s[8:11], s32 offen lds
    s_add_u32 m0, s30, 2048
    s_add_u32 s32, s31, 18432
    buffer_load_dwordx4 v8, s[8:11], s32 offen lds
    s_add_u32 m0, s30, 3072
    s_add_u32 s32, s31, 27648
    buffer_load_dwordx4 v9, s[8:11], s32 offen lds
    s_add_u32 m0, s30, 4096
    s_add_u32 s32, s31, 36864
    buffer_load_dwordx4 v8, s[8:11], s32 offen lds
    s_add_u32 m0, s30, 5120
    s_add_u32 s32, s31, 46080
    buffer_load_dwordx4 v9, s[8:11], s32 offen lds
    s_add_u32 m0, s30, 6144
    s_add_u32 s32, s31, 55296
    buffer_load_dwordx4 v8, s[8:11], s32 offen lds
    s_add_u32 m0, s30, 7168
    s_add_u32 s32, s31, 64512
    buffer_load_dwordx4 v9, s[8:11], s32 offen lds
mega_A6_xni:
    s_and_b32 s29, s28, 3
    s_mul_i32 s29, s29, 34816
    v_add_u32 v5, s29, v10
    v_add_u32 v6, s29, v11
    ds_read_b128 v[48:51], v5 offset:0
    ds_read_b128 v[52:55], v6 offset:0
    ds_read_b128 v[56:59], v5 offset:2048
    ds_read_b128 v[60:63], v6 offset:2048
    ds_read_b128 v[64:67], v5 offset:4096
    ds_read_b128 v[68:71], v6 offset:4096
    ds_read_b128 v[72:75], v5 offset:6144
    ds_read_b128 v[76:79], v6 offset:6144
    s_waitcnt lgkmcnt(6)
    v_mfma_f32_16x16x32_bf16 v[16:19], v[80:83], v[48:51], v[16:19]
    v_mfma_f32_16x16x32_bf16 v[20:23], v[48:51], v[48:51], v[20:23]
    v_mfma_f32_16x16x32_bf16 v[16:19], v[80:83], v[52:55], v[16:19]
    v_mfma_f32_16x16x32_bf16 v[20:23], v[52:55], v[52:55], v[20:23]
    s_waitcnt lgkmcnt(4)
    v_mfma_f32_16x16x32_bf16 v[24:27], v[80:83], v[56:59], v[24:27]
    v_mfma_f32_16x16x32_bf16 v[28:31], v[56:59], v[56:59], v[28:31]
    v_mfma_f32_16x16x32_bf16 v[24:27], v[80:83], v[60:63], v[24:27]
    v_mfma_f32_16x16x32_bf16 v[28:31], v[60:63], v[60:63], v[28:31]
    s_waitcnt lgkmcnt(2)
    v_mfma_f32_16x16x32_bf16 v[32:35], v[80:83], v[64:67], v[32:35]
    v_mfma_f32_16x16x32_bf16 v[36:39], v[64:67], v[64:67], v[36:39]
    v_mfma_f32_16x16x32_bf16 v[32:35], v[80:83], v[68:71], v[32:35]
    v_mfma_f32_16x16x32_bf16 v[36:39], v[68:71], v[68:71], v[36:39]
    s_waitcnt lgkmcnt(0)
    v_mfma_f32_16x16x32_bf16 v[40:43], v[80:83], v[72:75], v[40:43]
    v_mfma_f32_16x16x32_bf16 v[44:47], v[72:75], v[72:75], v[44:47]
    v_mfma_f32_16x16x32_bf16 v[40:43], v[80:83], v[76:79], v[40:43]
    v_mfma_f32_16x16x32_bf16 v[44:47], v[76:79], v[76:79], v[44:47]
    s_add_u32 s28, s28, 1
    s_cmp_lt_u32 s28, 9
    s_cbranch_scc1 mega_A6_xl
    s_nop 7
    s_nop 1
    v_and_b32 v5, 3, v3
    v_lshrrev_b32 v6, 2, v3
    v_cmp_eq_u32 vcc, v6, v4
    s_mov_b64 s[34:35], vcc
    v_cmp_eq_u32 vcc, 1, v5
    s_mov_b64 s[36:37], vcc
    v_cmp_eq_u32 vcc, 2, v5
    s_mov_b64 s[38:39], vcc
    v_cmp_eq_u32 vcc, 3, v5
    s_mov_b64 s[40:41], vcc
    s_nop 1
    v_cndmask_b32 v20, v20, v21, s[36:37]
    v_cndmask_b32 v20, v20, v22, s[38:39]
    v_cndmask_b32 v20, v20, v23, s[40:41]
    v_cndmask_b32 v20, 0, v20, s[34:35]
    v_mov_b32 v7, v20
    s_nop 1
    v_permlane16_swap_b32 v7, v20
    s_nop 1
    v_add_f32 v20, v20, v7
    v_mov_b32 v7, v20
    s_nop 1
    v_permlane32_swap_b32 v7, v20
    s_nop 1
    v_add_f32 v20, v20, v7
    v_mov_b32 v17, v20
    v_cndmask_b32 v28, v28, v29, s[36:37]
    v_cndmask_b32 v28, v28, v30, s[38:39]
    v_cndmask_b32 v28, v28, v31, s[40:41]
    v_cndmask_b32 v28, 0, v28, s[34:35]
    v_mov_b32 v7, v28
    s_nop 1
    v_permlane16_swap_b32 v7, v28
    s_nop 1
    v_add_f32 v28, v28, v7
    v_mov_b32 v7, v28
    s_nop 1
    v_permlane32_swap_b32 v7, v28
    s_nop 1
    v_add_f32 v28, v28, v7
    v_mov_b32 v25, v28
    v_cndmask_b32 v36, v36, v37, s[36:37]
    v_cndmask_b32 v36, v36, v38, s[38:39]
    v_cndmask_b32 v36, v36, v39, s[40:41]
    v_cndmask_b32 v36, 0, v36, s[34:35]
    v_mov_b32 v7, v36
    s_nop 1
    v_permlane16_swap_b32 v7, v36
    s_nop 1
    v_add_f32 v36, v36, v7
    v_mov_b32 v7, v36
    s_nop 1
    v_permlane32_swap_b32 v7, v36
    s_nop 1
    v_add_f32 v36, v36, v7
    v_mov_b32 v33, v36
    v_cndmask_b32 v44, v44, v45, s[36:37]
    v_cndmask_b32 v44, v44, v46, s[38:39]
    v_cndmask_b32 v44, v44, v47, s[40:41]
    v_cndmask_b32 v44, 0, v44, s[34:35]
    v_mov_b32 v7, v44
    s_nop 1
    v_permlane16_swap_b32 v7, v44
    s_nop 1
    v_add_f32 v44, v44, v7
    v_mov_b32 v7, v44
    s_nop 1
    v_permlane32_swap_b32 v7, v44
    s_nop 1
    v_add_f32 v44, v44, v7
    v_mov_b32 v41, v44
    s_lshl_b32 s29, s24, 9
    s_add_u32 s29, s29, 139264
    v_lshl_add_u32 v5, v3, 3, s29
    v_mov_b32 v8, 0
    v_mov_b32 v9, 0
    s_mov_b32 exec_lo, 0xffff
    s_mov_b32 exec_hi, 0x0
    ds_write_b64 v5, v[16:17] offset:0
    ds_write_b64 v5, v[8:9] offset:1024
    ds_write_b64 v5, v[24:25] offset:128
    ds_write_b64 v5, v[8:9] offset:1152
    ds_write_b64 v5, v[32:33] offset:256
    ds_write_b64 v5, v[8:9] offset:1280
    ds_write_b64 v5, v[40:41] offset:384
    ds_write_b64 v5, v[8:9] offset:1408
    s_mov_b64 exec, -1
    s_waitcnt lgkmcnt(0)
    s_branch mega_A6_ldone
mega_A6_wload:
    s_mov_b32 s8, s62
    s_mov_b32 s9, s63
    s_mov_b32 s10, 0x1e6000
    s_mov_b32 s11, 0x20000
    s_sub_u32 s25, s24, 2
    s_mul_i32 s26, s21, 288
    s_sub_u32 s27, s21, 4
    s_mul_i32 s27, s27, 144
    s_add_u32 s27, s27, 1152
    s_cmp_ge_u32 s21, 4
    s_cselect_b32 s26, s27, s26
    s_cselect_b32 s27, 1008, 0
    s_mul_i32 s29, s25, 110592
    s_add_u32 s26, s26, s29
    s_mov_b32 s34, s27
    s_mul_i32 s27, s25, 9216
    s_add_u32 s27, s27, 16384
    v_add_u32 v5, 0, v1
    v_mul_u32_u24 v6, 3641, v5
    v_lshrrev_b32 v6, 16, v6
    v_mul_u32_u24 v7, 18, v6
    v_sub_u32 v5, v5, v7
    v_and_b32 v7, 0x13, v6
    v_and_b32 v20, 4, v6
    v_lshl_or_b32 v7, v20, 1, v7
    v_and_b32 v20, 8, v6
    v_lshrrev_b32 v20, 1, v20
    v_or_b32 v7, v7, v20
    v_mul_u32_u24 v7, 3456, v7
    v_lshl_add_u32 v7, v5, 4, v7
    v_add_u32 v20, s34, v7
    v_cmp_le_u32 vcc, 9, v5
    s_add_u32 m0, s27, 0
    s_nop 0
    v_cndmask_b32 v8, v7, v20, vcc
    buffer_load_dwordx4 v8, s[8:11], s26 offen lds
    v_add_u32 v5, 64, v1
    v_mul_u32_u24 v6, 3641, v5
    v_lshrrev_b32 v6, 16, v6
    v_mul_u32_u24 v7, 18, v6
    v_sub_u32 v5, v5, v7
    v_and_b32 v7, 0x13, v6
    v_and_b32 v20, 4, v6
    v_lshl_or_b32 v7, v20, 1, v7
    v_and_b32 v20, 8, v6
    v_lshrrev_b32 v20, 1, v20
    v_or_b32 v7, v7, v20
    v_mul_u32_u24 v7, 3456, v7
    v_lshl_add_u32 v7, v5, 4, v7
    v_add_u32 v20, s34, v7
    v_cmp_le_u32 vcc, 9, v5
    s_add_u32 m0, s27, 1024
    s_nop 0
    v_cndmask_b32 v9, v7, v20, vcc
    buffer_load_dwordx4 v9, s[8:11], s26 offen lds
    v_add_u32 v5, 128, v1
    v_mul_u32_u24 v6, 3641, v5
    v_lshrrev_b32 v6, 16, v6
    v_mul_u32_u24 v7, 18, v6
    v_sub_u32 v5, v5, v7
    v_and_b32 v7, 0x13, v6
    v_and_b32 v20, 4, v6
    v_lshl_or_b32 v7, v20, 1, v7
    v_and_b32 v20, 8, v6
    v_lshrrev_b32 v20, 1, v20
    v_or_b32 v7, v7, v20
    v_mul_u32_u24 v7, 3456, v7
    v_lshl_add_u32 v7, v5, 4, v7
    v_add_u32 v20, s34, v7
    v_cmp_le_u32 vcc, 9, v5
    s_add_u32 m0, s27, 2048
    s_nop 0
    v_cndmask_b32 v10, v7, v20, vcc
    buffer_load_dwordx4 v10, s[8:11], s26 offen lds
    v_add_u32 v5, 192, v1
    v_mul_u32_u24 v6, 3641, v5
    v_lshrrev_b32 v6, 16, v6
    v_mul_u32_u24 v7, 18, v6
    v_sub_u32 v5, v5, v7
    v_and_b32 v7, 0x13, v6
    v_and_b32 v20, 4, v6
    v_lshl_or_b32 v7, v20, 1, v7
    v_and_b32 v20, 8, v6
    v_lshrrev_b32 v20, 1, v20
    v_or_b32 v7, v7, v20
    v_mul_u32_u24 v7, 3456, v7
    v_lshl_add_u32 v7, v5, 4, v7
    v_add_u32 v20, s34, v7
    v_cmp_le_u32 vcc, 9, v5
    s_add_u32 m0, s27, 3072
    s_nop 0
    v_cndmask_b32 v11, v7, v20, vcc
    buffer_load_dwordx4 v11, s[8:11], s26 offen lds
    v_add_u32 v5, 256, v1
    v_mul_u32_u24 v6, 3641, v5
    v_lshrrev_b32 v6, 16, v6
    v_mul_u32_u24 v7, 18, v6
    v_sub_u32 v5, v5, v7
    v_and_b32 v7, 0x13, v6
    v_and_b32 v20, 4, v6
    v_lshl_or_b32 v7, v20, 1, v7
    v_and_b32 v20, 8, v6
    v_lshrrev_b32 v20, 1, v20
    v_or_b32 v7, v7, v20
    v_mul_u32_u24 v7, 3456, v7
    v_lshl_add_u32 v7, v5, 4, v7
    v_add_u32 v20, s34, v7
    v_cmp_le_u32 vcc, 9, v5
    s_add_u32 m0, s27, 4096
    s_nop 0
    v_cndmask_b32 v12, v7, v20, vcc
    buffer_load_dwordx4 v12, s[8:11], s26 offen lds
    v_add_u32 v5, 320, v1
    v_mul_u32_u24 v6, 3641, v5
    v_lshrrev_b32 v6, 16, v6
    v_mul_u32_u24 v7, 18, v6
    v_sub_u32 v5, v5, v7
    v_and_b32 v7, 0x13, v6
    v_and_b32 v20, 4, v6
    v_lshl_or_b32 v7, v20, 1, v7
    v_and_b32 v20, 8, v6
    v_lshrrev_b32 v20, 1, v20
    v_or_b32 v7, v7, v20
    v_mul_u32_u24 v7, 3456, v7
    v_lshl_add_u32 v7, v5, 4, v7
    v_add_u32 v20, s34, v7
    v_cmp_le_u32 vcc, 9, v5
    s_add_u32 m0, s27, 5120
    s_nop 0
    v_cndmask_b32 v13, v7, v20, vcc
    buffer_load_dwordx4 v13, s[8:11], s26 offen lds
    v_add_u32 v5, 384, v1
    v_mul_u32_u24 v6, 3641, v5
    v_lshrrev_b32 v6, 16, v6
    v_mul_u32_u24 v7, 18, v6
    v_sub_u32 v5, v5, v7
    v_and_b32 v7, 0x13, v6
    v_and_b32 v20, 4, v6
    v_lshl_or_b32 v7, v20, 1, v7
    v_and_b32 v20, 8, v6
    v_lshrrev_b32 v20, 1, v20
    v_or_b32 v7, v7, v20
    v_mul_u32_u24 v7, 3456, v7
    v_lshl_add_u32 v7, v5, 4, v7
    v_add_u32 v20, s34, v7
    v_cmp_le_u32 vcc, 9, v5
    s_add_u32 m0, s27, 6144
    s_nop 0
    v_cndmask_b32 v14, v7, v20, vcc
    buffer_load_dwordx4 v14, s[8:11], s26 offen lds
    v_add_u32 v5, 448, v1
    v_mul_u32_u24 v6, 3641, v5
    v_lshrrev_b32 v6, 16, v6
    v_mul_u32_u24 v7, 18, v6
    v_sub_u32 v5, v5, v7
    v_and_b32 v7, 0x13, v6
    v_and_b32 v20, 4, v6
    v_lshl_or_b32 v7, v20, 1, v7
    v_and_b32 v20, 8, v6
    v_lshrrev_b32 v20, 1, v20
    v_or_b32 v7, v7, v20
    v_mul_u32_u24 v7, 3456, v7
    v_lshl_add_u32 v7, v5, 4, v7
    v_add_u32 v20, s34, v7
    v_cmp_le_u32 vcc, 9, v5
    s_add_u32 m0, s27, 7168
    s_nop 0
    v_cndmask_b32 v15, v7, v20, vcc
    buffer_load_dwordx4 v15, s[8:11], s26 offen lds
    v_add_u32 v5, 512, v1
    v_mul_u32_u24 v6, 3641, v5
    v_lshrrev_b32 v6, 16, v6
    v_mul_u32_u24 v7, 18, v6
    v_sub_u32 v5, v5, v7
    v_and_b32 v7, 0x13, v6
    v_and_b32 v20, 4, v6
    v_lshl_or_b32 v7, v20, 1, v7
    v_and_b32 v20, 8, v6
    v_lshrrev_b32 v20, 1, v20
    v_or_b32 v7, v7, v20
    v_mul_u32_u24 v7, 3456, v7
    v_lshl_add_u32 v7, v5, 4, v7
    v_add_u32 v20, s34, v7
    v_cmp_le_u32 vcc, 9, v5
    s_add_u32 m0, s27, 8192
    s_nop 0
    v_cndmask_b32 v16, v7, v20, vcc
    buffer_load_dwordx4 v16, s[8:11], s26 offen lds
    s_add_u32 s30, s27, 34816
    s_add_u32 s31, s26, 221184
    s_add_u32 m0, s30, 0
    s_nop 0
    buffer_load_dwordx4 v8, s[8:11], s31 offen lds
    s_add_u32 m0, s30, 1024
    s_nop 0
    buffer_load_dwordx4 v9, s[8:11], s31 offen lds
    s_add_u32 m0, s30, 2048
    s_nop 0
    buffer_load_dwordx4 v10, s[8:11], s31 offen lds
    s_add_u32 m0, s30, 3072
    s_nop 0
    buffer_load_dwordx4 v11, s[8:11], s31 offen lds
    s_add_u32 m0, s30, 4096
    s_nop 0
    buffer_load_dwordx4 v12, s[8:11], s31 offen lds
    s_add_u32 m0, s30, 5120
    s_nop 0
    buffer_load_dwordx4 v13, s[8:11], s31 offen lds
    s_add_u32 m0, s30, 6144
    s_nop 0
    buffer_load_dwordx4 v14, s[8:11], s31 offen lds
    s_add_u32 m0, s30, 7168
    s_nop 0
    buffer_load_dwordx4 v15, s[8:11], s31 offen lds
    s_add_u32 m0, s30, 8192
    s_nop 0
    buffer_load_dwordx4 v16, s[8:11], s31 offen lds
    v_lshrrev_b32 v20, 5, v1
    v_lshlrev_b32 v20, 4, v20
    v_bfe_u32 v5, v1, 4, 1
    v_lshl_add_u32 v20, v5, 2, v20
    v_bfe_u32 v5, v1, 2, 2
    v_add_u32 v20, v20, v5
    v_mul_u32_u24 v20, 288, v20
    v_and_b32 v5, 3, v1
    v_lshl_add_u32 v20, v5, 3, v20
    v_add_u32 v20, s27, v20
    v_mov_b32 v24, 0
    v_mov_b32 v25, 0
    v_mov_b32 v26, 0
    v_mov_b32 v27, 0
    v_mov_b32 v28, 0
    v_mov_b32 v29, 0
    v_mov_b32 v30, 0
    v_mov_b32 v31, 0
    v_mov_b32 v32, 0
    v_mov_b32 v33, 0
    v_mov_b32 v34, 0
    v_mov_b32 v35, 0
    v_mov_b32 v36, 0
    v_mov_b32 v37, 0
    v_mov_b32 v38, 0
    v_mov_b32 v39, 0
    v_mov_b32 v40, 0
    v_mov_b32 v41, 0
    v_mov_b32 v42, 0
    v_mov_b32 v43, 0
    v_mov_b32 v44, 0
    v_mov_b32 v45, 0
    v_mov_b32 v46, 0
    v_mov_b32 v47, 0
    v_mov_b32 v48, 0
    v_mov_b32 v49, 0
    v_mov_b32 v50, 0
    v_mov_b32 v51, 0
    v_mov_b32 v52, 0
    v_mov_b32 v53, 0
    v_mov_b32 v54, 0
    v_mov_b32 v55, 0
    v_mov_b32 v56, 0
    v_mov_b32 v57, 0
    v_mov_b32 v58, 0
    v_mov_b32 v59, 0
    v_mov_b32 v96, 0x3f803f80
    v_mov_b32 v97, 0x3f803f80
    v_mov_b32 v98, 0x3f803f80
    v_mov_b32 v99, 0x3f803f80
    v_mov_b32 v127, v8
    v_add_u32 v5, 0, v1
    v_mul_u32_u24 v6, 3641, v5
    v_lshrrev_b32 v6, 16, v6
    v_mul_u32_u24 v7, 18, v6
    v_sub_u32 v5, v5, v7
    v_lshlrev_b32 v110, 4, v5
    v_and_b32 v100, 0x13, v6
    v_and_b32 v8, 4, v6
    v_lshl_or_b32 v100, v8, 1, v100
    v_and_b32 v8, 8, v6
    v_lshrrev_b32 v8, 1, v8
    v_or_b32 v100, v100, v8
    v_add_u32 v5, 64, v1
    v_mul_u32_u24 v6, 3641, v5
    v_lshrrev_b32 v6, 16, v6
    v_mul_u32_u24 v7, 18, v6
    v_sub_u32 v5, v5, v7
    v_lshlrev_b32 v111, 4, v5
    v_and_b32 v101, 0x13, v6
    v_and_b32 v8, 4, v6
    v_lshl_or_b32 v101, v8, 1, v101
    v_and_b32 v8, 8, v6
    v_lshrrev_b32 v8, 1, v8
    v_or_b32 v101, v101, v8
    v_add_u32 v5, 128, v1
    v_mul_u32_u24 v6, 3641, v5
    v_lshrrev_b32 v6, 16, v6
    v_mul_u32_u24 v7, 18, v6
    v_sub_u32 v5, v5, v7
    v_lshlrev_b32 v112, 4, v5
    v_and_b32 v102, 0x13, v6
    v_and_b32 v8, 4, v6
    v_lshl_or_b32 v102, v8, 1, v102
    v_and_b32 v8, 8, v6
    v_lshrrev_b32 v8, 1, v8
    v_or_b32 v102, v102, v8
    v_add_u32 v5, 192, v1
    v_mul_u32_u24 v6, 3641, v5
    v_lshrrev_b32 v6, 16, v6
    v_mul_u32_u24 v7, 18, v6
    v_sub_u32 v5, v5, v7
    v_lshlrev_b32 v113, 4, v5
    v_and_b32 v103, 0x13, v6
    v_and_b32 v8, 4, v6
    v_lshl_or_b32 v103, v8, 1, v103
    v_and_b32 v8, 8, v6
    v_lshrrev_b32 v8, 1, v8
    v_or_b32 v103, v103, v8
    v_add_u32 v5, 256, v1
    v_mul_u32_u24 v6, 3641, v5
    v_lshrrev_b32 v6, 16, v6
    v_mul_u32_u24 v7, 18, v6
    v_sub_u32 v5, v5, v7
    v_lshlrev_b32 v114, 4, v5
    v_and_b32 v104, 0x13, v6
    v_and_b32 v8, 4, v6
    v_lshl_or_b32 v104, v8, 1, v104
    v_and_b32 v8, 8, v6
    v_lshrrev_b32 v8, 1, v8
    v_or_b32 v104, v104, v8
    v_add_u32 v5, 320, v1
    v_mul_u32_u24 v6, 3641, v5
    v_lshrrev_b32 v6, 16, v6
    v_mul_u32_u24 v7, 18, v6
    v_sub_u32 v5, v5, v7
    v_lshlrev_b32 v115, 4, v5
    v_and_b32 v105, 0x13, v6
    v_and_b32 v8, 4, v6
    v_lshl_or_b32 v105, v8, 1, v105
    v_and_b32 v8, 8, v6
    v_lshrrev_b32 v8, 1, v8
    v_or_b32 v105, v105, v8
    v_add_u32 v5, 384, v1
    v_mul_u32_u24 v6, 3641, v5
    v_lshrrev_b32 v6, 16, v6
    v_mul_u32_u24 v7, 18, v6
    v_sub_u32 v5, v5, v7
    v_lshlrev_b32 v116, 4, v5
    v_and_b32 v106, 0x13, v6
    v_and_b32 v8, 4, v6
    v_lshl_or_b32 v106, v8, 1, v106
    v_and_b32 v8, 8, v6
    v_lshrrev_b32 v8, 1, v8
    v_or_b32 v106, v106, v8
    v_add_u32 v5, 448, v1
    v_mul_u32_u24 v6, 3641, v5
    v_lshrrev_b32 v6, 16, v6
    v_mul_u32_u24 v7, 18, v6
    v_sub_u32 v5, v5, v7
    v_lshlrev_b32 v117, 4, v5
    v_and_b32 v107, 0x13, v6
    v_and_b32 v8, 4, v6
    v_lshl_or_b32 v107, v8, 1, v107
    v_and_b32 v8, 8, v6
    v_lshrrev_b32 v8, 1, v8
    v_or_b32 v107, v107, v8
    v_add_u32 v5, 512, v1
    v_mul_u32_u24 v6, 3641, v5
    v_lshrrev_b32 v6, 16, v6
    v_mul_u32_u24 v7, 18, v6
    v_sub_u32 v5, v5, v7
    v_lshlrev_b32 v118, 4, v5
    v_and_b32 v108, 0x13, v6
    v_and_b32 v8, 4, v6
    v_lshl_or_b32 v108, v8, 1, v108
    v_and_b32 v8, 8, v6
    v_lshrrev_b32 v8, 1, v8
    v_or_b32 v108, v108, v8
    v_mov_b32 v8, v127
    v_lshrrev_b32 v119, 5, v1
    v_lshlrev_b32 v119, 4, v119
    v_bfe_u32 v5, v1, 4, 1
    v_lshl_add_u32 v119, v5, 2, v119
    v_bfe_u32 v5, v1, 2, 2
    v_add_u32 v119, v119, v5
    v_mul_u32_u24 v119, 288, v119
    v_and_b32 v5, 3, v1
    v_lshl_add_u32 v119, v5, 3, v119
    s_cmp_lg_u32 s25, 0
    s_cbranch_scc1 mega_A6_nt
    v_lshlrev_b32 v5, 1, v1
    v_mul_u32_u24 v6, 3641, v5
    v_lshrrev_b32 v6, 16, v6
    v_mul_u32_u24 v7, 18, v6
    v_sub_u32 v7, v5, v7
    v_mul_u32_u24 v6, 768, v6
    v_lshrrev_b32 v21, 3, v7
    v_lshl_add_u32 v6, v21, 8, v6
    v_and_b32 v7, 7, v7
    v_lshl_add_u32 v6, v7, 1, v6
    v_lshlrev_b32 v7, 1, v5
    v_add_u32 v7, 139264, v7
    ds_write_b32 v7, v6 offset:3328
    v_add_u32 v5, 128, v5
    v_mul_u32_u24 v6, 3641, v5
    v_lshrrev_b32 v6, 16, v6
    v_mul_u32_u24 v7, 18, v6
    v_sub_u32 v7, v5, v7
    v_mul_u32_u24 v6, 768, v6
    v_lshrrev_b32 v21, 3, v7
    v_lshl_add_u32 v6, v21, 8, v6
    v_and_b32 v7, 7, v7
    v_lshl_add_u32 v6, v7, 1, v6
    v_lshlrev_b32 v7, 1, v5
    v_add_u32 v7, 139264, v7
    s_mov_b32 exec_lo, 0xff
    s_mov_b32 exec_hi, 0x0
    ds_write_b32 v7, v6 offset:3328
    s_mov_b64 exec, -1
mega_A6_nt:
    s_mov_b32 s28, 0
mega_A6_wl:
    s_cmp_le_u32 s28, 7
    s_cbranch_scc1 mega_A6_wb
    s_waitcnt vmcnt(9)
    s_branch mega_A6_wwd
mega_A6_wb:
    s_waitcnt vmcnt(9)
mega_A6_wwd:
    s_barrier
    s_cmp_gt_u32 s28, 6
    s_cbranch_scc1 mega_A6_wni
    s_add_u32 s29, s28, 2
    s_and_b32 s30, s29, 3
    s_mul_i32 s30, s30, 34816
    s_add_u32 s30, s30, s27
    s_mul_i32 s31, s29, 221184
    s_add_u32 s31, s31, s26
    s_add_u32 m0, s30, 0
    s_nop 0
    buffer_load_dwordx4 v8, s[8:11], s31 offen lds
    s_add_u32 m0, s30, 1024
    s_nop 0
    buffer_load_dwordx4 v9, s[8:11], s31 offen lds
    s_add_u32 m0, s30, 2048
    s_nop 0
    buffer_load_dwordx4 v10, s[8:11], s31 offen lds
    s_add_u32 m0, s30, 3072
    s_nop 0
    buffer_load_dwordx4 v11, s[8:11], s31 offen lds
    s_add_u32 m0, s30, 4096
    s_nop 0
    buffer_load_dwordx4 v12, s[8:11], s31 offen lds
    s_add_u32 m0, s30, 5120
    s_nop 0
    buffer_load_dwordx4 v13, s[8:11], s31 offen lds
    s_add_u32 m0, s30, 6144
    s_nop 0
    buffer_load_dwordx4 v14, s[8:11], s31 offen lds
    s_add_u32 m0, s30, 7168
    s_nop 0
    buffer_load_dwordx4 v15, s[8:11], s31 offen lds
    s_add_u32 m0, s30, 8192
    s_nop 0
    buffer_load_dwordx4 v16, s[8:11], s31 offen lds
mega_A6_wni:
    s_cmp_lg_u32 s28, 7
    s_cbranch_scc1 mega_xt7
    s_mov_b32 s44, s21
    s_mov_b32 s45, s26
    s_mov_b32 s49, s27
    s_mov_b32 s50, s28
    s_and_b32 s21, s2, 7
    s_lshr_b32 s46, s2, 3
    s_lshl_b32 s46, s46, 1
    s_add_u32 s46, s46, s25
    s_add_u32 s46, s46, 96
    s_mul_i32 s47, s25, 9216
    s_add_u32 s47, s47, 143360
    s_cmp_ge_u32 s46, 72
    s_cselect_b32 s23, 1, 0
    s_cselect_b32 s24, 72, 0
    s_sub_u32 s26, s46, s24
    s_lshr_b32 s27, s26, 2
    s_and_b32 s26, s26, 3
    s_mov_b32 s28, 9216
    s_cmp_eq_u32 s23, 1
    s_cselect_b32 s28, 1152, s28
    s_cselect_b32 s12, s72, s70
    s_cselect_b32 s13, s73, s71
    s_mov_b32 s14, 5308416
    s_mov_b32 s15, 0x20000
    s_mul_i32 s29, s27, 294912
    s_mul_i32 s30, s21, 1152
    s_add_u32 s29, s29, s30
    s_mul_i32 s30, s21, 663552
    s_mul_i32 s32, s27, 36864
    s_add_u32 s30, s30, s32
    s_cmp_eq_u32 s23, 1
    s_cselect_b32 s29, s30, s29
    s_mul_i32 s30, s26, 288
    s_add_u32 s29, s29, s30
    s_mul_i32 s32, s21, 12
    s_mul_i32 s33, s26, 3
    s_add_u32 s32, s32, s33
    s_mul_i32 s32, s32, 108
    s_mul_i32 s33, s23, 54
    s_add_u32 s32, s32, s33
    s_mul_i32 s33, s27, 3
    s_add_u32 s32, s32, s33
    s_lshl_b32 s32, s32, 10
    s_mov_b32 s48, s32
    v_mul_lo_u32 v7, v100, s28
    v_add_u32 v7, v7, v110
    s_add_u32 m0, s47, 0
    s_nop 0
    buffer_load_dwordx4 v7, s[12:15], s29 offen lds
    v_mul_lo_u32 v7, v101, s28
    v_add_u32 v7, v7, v111
    s_add_u32 m0, s47, 1024
    s_nop 0
    buffer_load_dwordx4 v7, s[12:15], s29 offen lds
    v_mul_lo_u32 v7, v102, s28
    v_add_u32 v7, v7, v112
    s_add_u32 m0, s47, 2048
    s_nop 0
    buffer_load_dwordx4 v7, s[12:15], s29 offen lds
    v_mul_lo_u32 v7, v103, s28
    v_add_u32 v7, v7, v113
    s_add_u32 m0, s47, 3072
    s_nop 0
    buffer_load_dwordx4 v7, s[12:15], s29 offen lds
    v_mul_lo_u32 v7, v104, s28
    v_add_u32 v7, v7, v114
    s_add_u32 m0, s47, 4096
    s_nop 0
    buffer_load_dwordx4 v7, s[12:15], s29 offen lds
    v_mul_lo_u32 v7, v105, s28
    v_add_u32 v7, v7, v115
    s_add_u32 m0, s47, 5120
    s_nop 0
    buffer_load_dwordx4 v7, s[12:15], s29 offen lds
    v_mul_lo_u32 v7, v106, s28
    v_add_u32 v7, v7, v116
    s_add_u32 m0, s47, 6144
    s_nop 0
    buffer_load_dwordx4 v7, s[12:15], s29 offen lds
    v_mul_lo_u32 v7, v107, s28
    v_add_u32 v7, v7, v117
    s_add_u32 m0, s47, 7168
    s_nop 0
    buffer_load_dwordx4 v7, s[12:15], s29 offen lds
    v_mul_lo_u32 v7, v108, s28
    v_add_u32 v7, v7, v118
    s_add_u32 m0, s47, 8192
    s_nop 0
    buffer_load_dwordx4 v7, s[12:15], s29 offen lds
    s_mov_b32 s21, s44
    s_mov_b32 s26, s45
    s_mov_b32 s27, s49
    s_mov_b32 s28, s50
mega_xt7:
    s_and_b32 s29, s28, 3
    s_mul_i32 s29, s29, 34816
    v_add_u32 v5, s29, v20
    ds_read_b64_tr_b16 v[60:61], v5 offset:0
    ds_read_b64_tr_b16 v[62:63], v5 offset:2304
    ds_read_b64_tr_b16 v[64:65], v5 offset:32
    ds_read_b64_tr_b16 v[66:67], v5 offset:2336
    ds_read_b64_tr_b16 v[68:69], v5 offset:64
    ds_read_b64_tr_b16 v[70:71], v5 offset:2368
    ds_read_b64_tr_b16 v[72:73], v5 offset:96
    ds_read_b64_tr_b16 v[74:75], v5 offset:2400
    ds_read_b64_tr_b16 v[76:77], v5 offset:128
    ds_read_b64_tr_b16 v[78:79], v5 offset:2432
    ds_read_b64_tr_b16 v[80:81], v5 offset:160
    ds_read_b64_tr_b16 v[82:83], v5 offset:2464
    ds_read_b64_tr_b16 v[84:85], v5 offset:192
    ds_read_b64_tr_b16 v[86:87], v5 offset:2496
    ds_read_b64_tr_b16 v[88:89], v5 offset:224
    ds_read_b64_tr_b16 v[90:91], v5 offset:2528
    ds_read_b64_tr_b16 v[92:93], v5 offset:256
    ds_read_b64_tr_b16 v[94:95], v5 offset:2560
    s_waitcnt lgkmcnt(15)
    v_mfma_f32_16x16x32_bf16 v[24:27], v[60:63], v[96:99], v[24:27]
    s_waitcnt lgkmcnt(14)
    v_mfma_f32_16x16x32_bf16 v[28:31], v[64:67], v[96:99], v[28:31]
    s_waitcnt lgkmcnt(12)
    v_mfma_f32_16x16x32_bf16 v[32:35], v[68:71], v[96:99], v[32:35]
    s_waitcnt lgkmcnt(10)
    v_mfma_f32_16x16x32_bf16 v[36:39], v[72:75], v[96:99], v[36:39]
    s_waitcnt lgkmcnt(8)
    v_mfma_f32_16x16x32_bf16 v[40:43], v[76:79], v[96:99], v[40:43]
    s_waitcnt lgkmcnt(6)
    v_mfma_f32_16x16x32_bf16 v[44:47], v[80:83], v[96:99], v[44:47]
    s_waitcnt lgkmcnt(4)
    v_mfma_f32_16x16x32_bf16 v[48:51], v[84:87], v[96:99], v[48:51]
    s_waitcnt lgkmcnt(2)
    v_mfma_f32_16x16x32_bf16 v[52:55], v[88:91], v[96:99], v[52:55]
    s_waitcnt lgkmcnt(0)
    v_mfma_f32_16x16x32_bf16 v[56:59], v[92:95], v[96:99], v[56:59]
    s_add_u32 s28, s28, 1
    s_cmp_lt_u32 s28, 9
    s_cbranch_scc1 mega_A6_wl
    s_mul_i32 s29, s25, 640
    s_add_u32 s29, s29, 141312
    v_lshlrev_b32 v5, 4, v4
    v_add_u32 v5, s29, v5
    v_cmp_eq_u32 vcc, 0, v3
    s_nop 7
    s_mov_b64 exec, vcc
    ds_write_b128 v5, v[24:27] offset:0
    ds_write_b128 v5, v[28:31] offset:64
    ds_write_b128 v5, v[32:35] offset:128
    ds_write_b128 v5, v[36:39] offset:192
    ds_write_b128 v5, v[40:43] offset:256
    ds_write_b128 v5, v[44:47] offset:320
    ds_write_b128 v5, v[48:51] offset:384
    ds_write_b128 v5, v[52:55] offset:448
    ds_write_b128 v5, v[56:59] offset:512
    s_mov_b64 exec, -1
    s_waitcnt lgkmcnt(0)
mega_A6_ldone:
    s_barrier
    s_barrier
    s_cmp_ge_u32 s21, 4
    s_cbranch_scc0 mega_A6_join
    s_barrier
mega_A6_join:
    s_cmp_ge_u32 s21, 4
    s_cbranch_scc0 mega_A6_end
    s_barrier
    v_and_b32 v1, 63, v0
    v_lshlrev_b32 v2, 4, v1
    v_and_b32 v3, 15, v1
    v_lshrrev_b32 v4, 4, v1
    s_add_u32 s8, s4, 0x28c0000
    s_addc_u32 s9, s5, 0
    s_mov_b32 s10, 0xf000
    s_mov_b32 s11, 0x20000
    s_sub_u32 s26, s21, 4
    s_lshl_b32 s26, s26, 2
    v_add_u32 v5, 0, v0
    v_mul_u32_u24 v6, 49057, v5
    v_lshrrev_b32 v6, 24, v6
    v_mul_u32_u24 v7, 342, v6
    v_sub_u32 v7, v5, v7
    v_mul_u32_u24 v8, 3641, v7
    v_lshrrev_b32 v8, 16, v8
    v_mul_u32_u24 v9, 18, v8
    v_sub_u32 v9, v7, v9
    v_mul_u32_u24 v10, 18, v6
    v_add_u32 v11, v10, v8
    v_add_u32 v11, 8, v11
    v_cmp_eq_u32 vcc, 18, v8
    s_mov_b64 s[36:37], vcc
    v_add_u32 v12, v10, v9
    v_cndmask_b32 v11, v11, 0, vcc
    v_lshrrev_b32 v14, 4, v12
    v_lshrrev_b32 v15, 4, v11
    v_lshlrev_b32 v16, 1, v14
    v_add_u32 v16, v16, v15
    v_add_u32 v16, 1, v16
    v_add_u32 v17, 12, v14
    v_cmp_le_u32 vcc, 2, v14
    s_and_b64 vcc, vcc, s[36:37]
    s_nop 1
    v_cndmask_b32 v16, v16, v17, vcc
    v_cmp_eq_u32 vcc, 4, v14
    s_and_b64 vcc, vcc, s[36:37]
    s_nop 1
    v_cndmask_b32 v16, v16, 0, vcc
    v_lshlrev_b32 v16, 10, v16
    v_bfe_u32 v17, v11, 2, 2
    v_lshl_add_u32 v16, v17, 8, v16
    v_and_b32 v17, 15, v12
    v_lshl_add_u32 v16, v17, 4, v16
    v_and_b32 v17, 3, v11
    v_lshl_add_u32 v16, v17, 2, v16
    v_add_u32 v17, 0x10000, v16
    ds_read_b32 v20, v16
    ds_read_b32 v21, v16 offset:16384
    ds_read_b32 v22, v16 offset:32768
    ds_read_b32 v23, v16 offset:49152
    ds_read_b32 v24, v17
    ds_read_b32 v25, v17 offset:16384
    ds_read_b32 v26, v17 offset:32768
    ds_read_b32 v27, v17 offset:49152
    v_add_u32 v6, s26, v6
    v_mul_u32_u24 v6, 20, v6
    v_add_u32 v6, v6, v8
    v_mul_u32_u24 v6, 24, v6
    v_add_u32 v6, v6, v9
    v_lshlrev_b32 v6, 2, v6
    v_cmp_gt_u32 vcc, 1368, v5
    s_waitcnt lgkmcnt(0)
    v_add_f32 v20, v20, v21
    v_add_f32 v22, v22, v23
    v_add_f32 v24, v24, v25
    v_add_f32 v26, v26, v27
    v_add_f32 v20, v20, v22
    v_add_f32 v24, v24, v26
    v_add_f32 v13, v20, v24
    s_and_saveexec_b64 s[34:35], vcc
    s_cbranch_execz mega_A6_ns0
    buffer_atomic_add_f32 v13, v6, s[8:11], 0 offen
mega_A6_ns0:
    s_mov_b64 exec, -1
    v_add_u32 v5, 768, v0
    v_mul_u32_u24 v6, 49057, v5
    v_lshrrev_b32 v6, 24, v6
    v_mul_u32_u24 v7, 342, v6
    v_sub_u32 v7, v5, v7
    v_mul_u32_u24 v8, 3641, v7
    v_lshrrev_b32 v8, 16, v8
    v_mul_u32_u24 v9, 18, v8
    v_sub_u32 v9, v7, v9
    v_mul_u32_u24 v10, 18, v6
    v_add_u32 v11, v10, v8
    v_add_u32 v11, 8, v11
    v_cmp_eq_u32 vcc, 18, v8
    s_mov_b64 s[36:37], vcc
    v_add_u32 v12, v10, v9
    v_cndmask_b32 v11, v11, 0, vcc
    v_lshrrev_b32 v14, 4, v12
    v_lshrrev_b32 v15, 4, v11
    v_lshlrev_b32 v16, 1, v14
    v_add_u32 v16, v16, v15
    v_add_u32 v16, 1, v16
    v_add_u32 v17, 12, v14
    v_cmp_le_u32 vcc, 2, v14
    s_and_b64 vcc, vcc, s[36:37]
    s_nop 1
    v_cndmask_b32 v16, v16, v17, vcc
    v_cmp_eq_u32 vcc, 4, v14
    s_and_b64 vcc, vcc, s[36:37]
    s_nop 1
    v_cndmask_b32 v16, v16, 0, vcc
    v_lshlrev_b32 v16, 10, v16
    v_bfe_u32 v17, v11, 2, 2
    v_lshl_add_u32 v16, v17, 8, v16
    v_and_b32 v17, 15, v12
    v_lshl_add_u32 v16, v17, 4, v16
    v_and_b32 v17, 3, v11
    v_lshl_add_u32 v16, v17, 2, v16
    v_add_u32 v17, 0x10000, v16
    ds_read_b32 v20, v16
    ds_read_b32 v21, v16 offset:16384
    ds_read_b32 v22, v16 offset:32768
    ds_read_b32 v23, v16 offset:49152
    ds_read_b32 v24, v17
    ds_read_b32 v25, v17 offset:16384
    ds_read_b32 v26, v17 offset:32768
    ds_read_b32 v27, v17 offset:49152
    v_add_u32 v6, s26, v6
    v_mul_u32_u24 v6, 20, v6
    v_add_u32 v6, v6, v8
    v_mul_u32_u24 v6, 24, v6
    v_add_u32 v6, v6, v9
    v_lshlrev_b32 v6, 2, v6
    v_cmp_gt_u32 vcc, 1368, v5
    s_waitcnt lgkmcnt(0)
    v_add_f32 v20, v20, v21
    v_add_f32 v22, v22, v23
    v_add_f32 v24, v24, v25
    v_add_f32 v26, v26, v27
    v_add_f32 v20, v20, v22
    v_add_f32 v24, v24, v26
    v_add_f32 v13, v20, v24
    s_and_saveexec_b64 s[34:35], vcc
    s_cbranch_execz mega_A6_ns1
    buffer_atomic_add_f32 v13, v6, s[8:11], 0 offen
mega_A6_ns1:
    s_mov_b64 exec, -1
mega_A6_end:
    s_cmp_lt_u32 s22, 10
    s_cbranch_scc1 mega_aw8
    s_cmp_ge_u32 s21, 4
    s_cbranch_scc1 mega_aw8
    s_branch mega_aw8n
mega_aw8:
    s_waitcnt vmcnt(0)
mega_aw8n:
    s_barrier
    s_cmp_lg_u32 s22, 0
    s_cbranch_scc1 mega_ag9
    v_mov_b32 v5, 16384
    v_mov_b32 v6, 1
    s_mov_b64 exec, 1
    buffer_atomic_add v6, v5, s[84:87], 0 offen sc0 sc1
    s_waitcnt vmcnt(0)
    v_readfirstlane_b32 s82, v6
    s_cmp_lg_u32 s82, 255
    s_cbranch_scc1 mega_ag9_n
    v_mov_b32 v5, 16512
    v_mov_b32 v6, 1
    buffer_store_dword v6, v5, s[84:87], 0 offen sc1
mega_ag9_n:
    s_mov_b64 exec, -1
mega_ag9:
mega_PA2_k:
    s_cmp_lt_u32 s22, 10
    s_cbranch_scc1 mega_PA2_j
    v_and_b32 v1, 63, v0
    v_lshlrev_b32 v2, 4, v1
    v_and_b32 v3, 15, v1
    v_lshrrev_b32 v4, 4, v1
    s_mov_b32 s16, s4
    s_mov_b32 s17, s5
    s_mov_b32 s18, 0xa20000
    s_mov_b32 s19, 0x20000
    s_waitcnt vmcnt(0)
    v_add_u32 v6, s47, v119
    ds_read_b64_tr_b16 v[64:65], v6 offset:0
    ds_read_b64_tr_b16 v[66:67], v6 offset:2304
    ds_read_b64_tr_b16 v[68:69], v6 offset:32
    ds_read_b64_tr_b16 v[70:71], v6 offset:2336
    ds_read_b64_tr_b16 v[72:73], v6 offset:64
    ds_read_b64_tr_b16 v[74:75], v6 offset:2368
    ds_read_b64_tr_b16 v[76:77], v6 offset:96
    ds_read_b64_tr_b16 v[78:79], v6 offset:2400
    ds_read_b64_tr_b16 v[80:81], v6 offset:128
    ds_read_b64_tr_b16 v[82:83], v6 offset:2432
    ds_read_b64_tr_b16 v[84:85], v6 offset:160
    ds_read_b64_tr_b16 v[86:87], v6 offset:2464
    ds_read_b64_tr_b16 v[88:89], v6 offset:192
    ds_read_b64_tr_b16 v[90:91], v6 offset:2496
    ds_read_b64_tr_b16 v[92:93], v6 offset:224
    ds_read_b64_tr_b16 v[94:95], v6 offset:2528
    ds_read_b64_tr_b16 v[96:97], v6 offset:256
    ds_read_b64_tr_b16 v[98:99], v6 offset:2560
    s_waitcnt lgkmcnt(0)
    s_add_u32 s33, s48, 0
    buffer_store_dwordx4 v[64:67], v2, s[16:19], s33 offen offset:0 sc1
    buffer_store_dwordx4 v[68:71], v2, s[16:19], s33 offen offset:1024 sc1
    buffer_store_dwordx4 v[72:75], v2, s[16:19], s33 offen offset:2048 sc1
    s_add_u32 s33, s48, 110592
    buffer_store_dwordx4 v[76:79], v2, s[16:19], s33 offen offset:0 sc1
    buffer_store_dwordx4 v[80:83], v2, s[16:19], s33 offen offset:1024 sc1
    buffer_store_dwordx4 v[84:87], v2, s[16:19], s33 offen offset:2048 sc1
    s_add_u32 s33, s48, 221184
    buffer_store_dwordx4 v[88:91], v2, s[16:19], s33 offen offset:0 sc1
    buffer_store_dwordx4 v[92:95], v2, s[16:19], s33 offen offset:1024 sc1
    buffer_store_dwordx4 v[96:99], v2, s[16:19], s33 offen offset:2048 sc1
    s_branch mega_PA2_j
mega_PA2_h:
    v_and_b32 v1, 63, v0
    v_lshlrev_b32 v2, 4, v1
    v_and_b32 v3, 15, v1
    v_lshrrev_b32 v4, 4, v1
    s_sub_u32 s20, s2, 192
    v_add_u32 v5, 0, v1
    v_mul_u32_u24 v6, 3641, v5
    v_lshrrev_b32 v6, 16, v6
    v_mul_u32_u24 v7, 18, v6
    v_sub_u32 v5, v5, v7
    v_lshlrev_b32 v50, 4, v5
    v_and_b32 v40, 0x13, v6
    v_and_b32 v8, 4, v6
    v_lshl_or_b32 v40, v8, 1, v40
    v_and_b32 v8, 8, v6
    v_lshrrev_b32 v8, 1, v8
    v_or_b32 v40, v40, v8
    v_add_u32 v5, 64, v1
    v_mul_u32_u24 v6, 3641, v5
    v_lshrrev_b32 v6, 16, v6
    v_mul_u32_u24 v7, 18, v6
    v_sub_u32 v5, v5, v7
    v_lshlrev_b32 v51, 4, v5
    v_and_b32 v41, 0x13, v6
    v_and_b32 v8, 4, v6
    v_lshl_or_b32 v41, v8, 1, v41
    v_and_b32 v8, 8, v6
    v_lshrrev_b32 v8, 1, v8
    v_or_b32 v41, v41, v8
    v_add_u32 v5, 128, v1
    v_mul_u32_u24 v6, 3641, v5
    v_lshrrev_b32 v6, 16, v6
    v_mul_u32_u24 v7, 18, v6
    v_sub_u32 v5, v5, v7
    v_lshlrev_b32 v52, 4, v5
    v_and_b32 v42, 0x13, v6
    v_and_b32 v8, 4, v6
    v_lshl_or_b32 v42, v8, 1, v42
    v_and_b32 v8, 8, v6
    v_lshrrev_b32 v8, 1, v8
    v_or_b32 v42, v42, v8
    v_add_u32 v5, 192, v1
    v_mul_u32_u24 v6, 3641, v5
    v_lshrrev_b32 v6, 16, v6
    v_mul_u32_u24 v7, 18, v6
    v_sub_u32 v5, v5, v7
    v_lshlrev_b32 v53, 4, v5
    v_and_b32 v43, 0x13, v6
    v_and_b32 v8, 4, v6
    v_lshl_or_b32 v43, v8, 1, v43
    v_and_b32 v8, 8, v6
    v_lshrrev_b32 v8, 1, v8
    v_or_b32 v43, v43, v8
    v_add_u32 v5, 256, v1
    v_mul_u32_u24 v6, 3641, v5
    v_lshrrev_b32 v6, 16, v6
    v_mul_u32_u24 v7, 18, v6
    v_sub_u32 v5, v5, v7
    v_lshlrev_b32 v54, 4, v5
    v_and_b32 v44, 0x13, v6
    v_and_b32 v8, 4, v6
    v_lshl_or_b32 v44, v8, 1, v44
    v_and_b32 v8, 8, v6
    v_lshrrev_b32 v8, 1, v8
    v_or_b32 v44, v44, v8
    v_add_u32 v5, 320, v1
    v_mul_u32_u24 v6, 3641, v5
    v_lshrrev_b32 v6, 16, v6
    v_mul_u32_u24 v7, 18, v6
    v_sub_u32 v5, v5, v7
    v_lshlrev_b32 v55, 4, v5
    v_and_b32 v45, 0x13, v6
    v_and_b32 v8, 4, v6
    v_lshl_or_b32 v45, v8, 1, v45
    v_and_b32 v8, 8, v6
    v_lshrrev_b32 v8, 1, v8
    v_or_b32 v45, v45, v8
    v_add_u32 v5, 384, v1
    v_mul_u32_u24 v6, 3641, v5
    v_lshrrev_b32 v6, 16, v6
    v_mul_u32_u24 v7, 18, v6
    v_sub_u32 v5, v5, v7
    v_lshlrev_b32 v56, 4, v5
    v_and_b32 v46, 0x13, v6
    v_and_b32 v8, 4, v6
    v_lshl_or_b32 v46, v8, 1, v46
    v_and_b32 v8, 8, v6
    v_lshrrev_b32 v8, 1, v8
    v_or_b32 v46, v46, v8
    v_add_u32 v5, 448, v1
    v_mul_u32_u24 v6, 3641, v5
    v_lshrrev_b32 v6, 16, v6
    v_mul_u32_u24 v7, 18, v6
    v_sub_u32 v5, v5, v7
    v_lshlrev_b32 v57, 4, v5
    v_and_b32 v47, 0x13, v6
    v_and_b32 v8, 4, v6
    v_lshl_or_b32 v47, v8, 1, v47
    v_and_b32 v8, 8, v6
    v_lshrrev_b32 v8, 1, v8
    v_or_b32 v47, v47, v8
    v_add_u32 v5, 512, v1
    v_mul_u32_u24 v6, 3641, v5
    v_lshrrev_b32 v6, 16, v6
    v_mul_u32_u24 v7, 18, v6
    v_sub_u32 v5, v5, v7
    v_lshlrev_b32 v58, 4, v5
    v_and_b32 v48, 0x13, v6
    v_and_b32 v8, 4, v6
    v_lshl_or_b32 v48, v8, 1, v48
    v_and_b32 v8, 8, v6
    v_lshrrev_b32 v8, 1, v8
    v_or_b32 v48, v48, v8
    v_lshrrev_b32 v59, 5, v1
    v_lshlrev_b32 v59, 4, v59
    v_bfe_u32 v5, v1, 4, 1
    v_lshl_add_u32 v59, v5, 2, v59
    v_bfe_u32 v5, v1, 2, 2
    v_add_u32 v59, v59, v5
    v_mul_u32_u24 v59, 288, v59
    v_and_b32 v5, 3, v1
    v_lshl_add_u32 v59, v5, 3, v59
    s_mov_b32 s16, s4
    s_mov_b32 s17, s5
    s_mov_b32 s18, 0xa20000
    s_mov_b32 s19, 0x20000
    s_and_b32 s21, s20, 7
    s_lshr_b32 s25, s20, 3
    s_mul_i32 s25, s25, 12
    s_add_u32 s25, s25, s22
    s_mul_i32 s34, s22, 9216
    s_cmp_ge_u32 s25, 72
    s_cselect_b32 s23, 1, 0
    s_cselect_b32 s24, 72, 0
    s_sub_u32 s26, s25, s24
    s_lshr_b32 s27, s26, 2
    s_and_b32 s26, s26, 3
    s_mov_b32 s28, 9216
    s_cmp_eq_u32 s23, 1
    s_cselect_b32 s28, 1152, s28
    s_cselect_b32 s12, s72, s70
    s_cselect_b32 s13, s73, s71
    s_mov_b32 s14, 5308416
    s_mov_b32 s15, 0x20000
    s_mul_i32 s29, s27, 294912
    s_mul_i32 s30, s21, 1152
    s_add_u32 s29, s29, s30
    s_mul_i32 s30, s21, 663552
    s_mul_i32 s32, s27, 36864
    s_add_u32 s30, s30, s32
    s_cmp_eq_u32 s23, 1
    s_cselect_b32 s29, s30, s29
    s_mul_i32 s30, s26, 288
    s_add_u32 s29, s29, s30
    s_mul_i32 s32, s21, 12
    s_mul_i32 s33, s26, 3
    s_add_u32 s32, s32, s33
    s_mul_i32 s32, s32, 108
    s_mul_i32 s33, s23, 54
    s_add_u32 s32, s32, s33
    s_mul_i32 s33, s27, 3
    s_add_u32 s32, s32, s33
    s_lshl_b32 s32, s32, 10
    s_mov_b32 s36, s32
    v_mul_lo_u32 v7, v40, s28
    v_add_u32 v7, v7, v50
    s_add_u32 m0, s34, 0
    s_nop 0
    buffer_load_dwordx4 v7, s[12:15], s29 offen lds
    v_mul_lo_u32 v7, v41, s28
    v_add_u32 v7, v7, v51
    s_add_u32 m0, s34, 1024
    s_nop 0
    buffer_load_dwordx4 v7, s[12:15], s29 offen lds
    v_mul_lo_u32 v7, v42, s28
    v_add_u32 v7, v7, v52
    s_add_u32 m0, s34, 2048
    s_nop 0
    buffer_load_dwordx4 v7, s[12:15], s29 offen lds
    v_mul_lo_u32 v7, v43, s28
    v_add_u32 v7, v7, v53
    s_add_u32 m0, s34, 3072
    s_nop 0
    buffer_load_dwordx4 v7, s[12:15], s29 offen lds
    v_mul_lo_u32 v7, v44, s28
    v_add_u32 v7, v7, v54
    s_add_u32 m0, s34, 4096
    s_nop 0
    buffer_load_dwordx4 v7, s[12:15], s29 offen lds
    v_mul_lo_u32 v7, v45, s28
    v_add_u32 v7, v7, v55
    s_add_u32 m0, s34, 5120
    s_nop 0
    buffer_load_dwordx4 v7, s[12:15], s29 offen lds
    v_mul_lo_u32 v7, v46, s28
    v_add_u32 v7, v7, v56
    s_add_u32 m0, s34, 6144
    s_nop 0
    buffer_load_dwordx4 v7, s[12:15], s29 offen lds
    v_mul_lo_u32 v7, v47, s28
    v_add_u32 v7, v7, v57
    s_add_u32 m0, s34, 7168
    s_nop 0
    buffer_load_dwordx4 v7, s[12:15], s29 offen lds
    v_mul_lo_u32 v7, v48, s28
    v_add_u32 v7, v7, v58
    s_add_u32 m0, s34, 8192
    s_nop 0
    buffer_load_dwordx4 v7, s[12:15], s29 offen lds
    s_mul_i32 s38, s20, 768
    v_add_u32 v5, s38, v0
    s_mov_b32 s8, s64
    s_mov_b32 s9, s65
    s_mov_b32 s10, 0xa2000
    s_mov_b32 s11, 0x20000
    v_cvt_f32_u32 v6, v5
    v_add_f32 v6, 0.5, v6
    v_mul_f32 v6, 0x392c7692, v6
    v_cvt_u32_f32 v6, v6
    v_mul_u32_u24 v7, 6080, v6
    v_sub_u32 v7, v5, v7
    v_mul_u32_u24 v8, 6554, v7
    v_lshrrev_b32 v8, 16, v8
    v_mul_u32_u24 v9, 10, v8
    v_sub_u32 v9, v7, v9
    v_and_b32 v12, 31, v8
    v_and_b32 v13, 0x13, v12
    v_and_b32 v14, 4, v12
    v_lshl_or_b32 v13, v14, 1, v13
    v_and_b32 v14, 8, v12
    v_lshrrev_b32 v14, 1, v14
    v_or_b32 v13, v13, v14
    v_lshrrev_b32 v12, 5, v8
    v_mov_b32 v14, 0
    v_mov_b32 v15, 0
    v_mov_b32 v16, 6
    v_cmp_le_u32 vcc, 7, v12
    s_nop 1
    v_cndmask_b32 v14, v14, 12, vcc
    v_cndmask_b32 v15, v15, 7, vcc
    v_cndmask_b32 v16, v16, 5, vcc
    v_cmp_le_u32 vcc, 13, v12
    s_nop 1
    v_cndmask_b32 v14, v14, 22, vcc
    v_cndmask_b32 v15, v15, 13, vcc
    v_sub_u32 v12, v12, v15
    v_lshrrev_b32 v15, 3, v13
    v_and_b32 v13, 7, v13
    v_lshl_add_u32 v10, v12, 1, v14
    v_lshrrev_b32 v17, 2, v13
    v_add_u32 v10, v10, v17
    v_mul_u32_u24 v10, 18, v10
    v_lshl_add_u32 v10, v15, 2, v10
    v_and_b32 v17, 3, v13
    v_add_u32 v10, v10, v17
    v_cmp_eq_u32 vcc, v12, v16
    v_lshrrev_b32 v12, 1, v13
    v_lshl_add_u32 v12, v12, 2, v15
    v_lshlrev_b32 v16, 1, v16
    v_add_u32 v14, v14, v12
    v_mul_u32_u24 v14, 18, v14
    v_and_b32 v13, 1, v13
    v_add_u32 v14, v14, v13
    v_add_u32 v14, 16, v14
    v_cndmask_b32 v10, v10, v14, vcc
    s_mov_b64 s[50:51], vcc
    v_cmp_ge_u32 vcc, v12, v16
    s_and_b64 vcc, vcc, s[50:51]
    v_mov_b32 v13, 0x100000
    s_nop 1
    v_cndmask_b32 v10, v10, v13, vcc
    v_mul_u32_u24 v11, 1152, v10
    v_mul_u32_u24 v12, 144, v6
    v_add_u32 v11, v11, v12
    v_lshl_add_u32 v11, v9, 4, v11
    buffer_load_dwordx4 v[20:23], v11, s[8:11], 0 offen
    v_lshlrev_b32 v32, 4, v5
    v_cmp_gt_u32 vcc, 48640, v5
    s_mov_b64 s[30:31], vcc
    v_cmp_ne_u32 vcc, 9, v9
    s_and_b64 vcc, vcc, s[30:31]
    v_mov_b32 v35, 0x7fff0000
    s_nop 0
    v_cndmask_b32 v32, v35, v32, vcc
    s_mov_b32 s8, s66
    s_mov_b32 s9, s67
    s_mov_b32 s10, 0xa2000
    s_mov_b32 s11, 0x20000
    v_cvt_f32_u32 v6, v5
    v_add_f32 v6, 0.5, v6
    v_mul_f32 v6, 0x39360b61, v6
    v_cvt_u32_f32 v6, v6
    v_mul_u32_u24 v7, 5760, v6
    v_sub_u32 v7, v5, v7
    v_mul_u32_u24 v8, 6554, v7
    v_lshrrev_b32 v8, 16, v8
    v_mul_u32_u24 v9, 10, v8
    v_sub_u32 v9, v7, v9
    v_and_b32 v12, 31, v8
    v_and_b32 v13, 0x13, v12
    v_and_b32 v14, 4, v12
    v_lshl_or_b32 v13, v14, 1, v13
    v_and_b32 v14, 8, v12
    v_lshrrev_b32 v14, 1, v14
    v_or_b32 v13, v13, v14
    v_lshrrev_b32 v12, 5, v8
    v_lshl_add_u32 v10, v12, 5, v13
    v_mul_u32_u24 v11, 1152, v10
    v_mul_u32_u24 v12, 144, v6
    v_add_u32 v11, v11, v12
    v_lshl_add_u32 v11, v9, 4, v11
    buffer_load_dwordx4 v[24:27], v11, s[8:11], 0 offen
    v_lshlrev_b32 v33, 4, v5
    v_cmp_gt_u32 vcc, 46080, v5
    v_mov_b32 v35, 0x7fff0000
    s_nop 0
    v_cndmask_b32 v33, v35, v33, vcc
    s_mov_b32 s8, s68
    s_mov_b32 s9, s69
    s_mov_b32 s10, 0xa2000
    s_mov_b32 s11, 0x20000
    v_cvt_f32_u32 v6, v5
    v_add_f32 v6, 0.5, v6
    v_mul_f32 v6, 0x39360b61, v6
    v_cvt_u32_f32 v6, v6
    v_mul_u32_u24 v7, 5760, v6
    v_sub_u32 v7, v5, v7
    v_mul_u32_u24 v8, 6554, v7
    v_lshrrev_b32 v8, 16, v8
    v_mul_u32_u24 v9, 10, v8
    v_sub_u32 v9, v7, v9
    v_and_b32 v12, 31, v8
    v_and_b32 v13, 0x13, v12
    v_and_b32 v14, 4, v12
    v_lshl_or_b32 v13, v14, 1, v13
    v_and_b32 v14, 8, v12
    v_lshrrev_b32 v14, 1, v14
    v_or_b32 v13, v13, v14
    v_lshrrev_b32 v12, 5, v8
    v_lshl_add_u32 v10, v12, 5, v13
    v_mul_u32_u24 v11, 1152, v10
    v_mul_u32_u24 v12, 144, v6
    v_add_u32 v11, v11, v12
    v_lshl_add_u32 v11, v9, 4, v11
    buffer_load_dwordx4 v[28:31], v11, s[8:11], 0 offen
    v_lshlrev_b32 v34, 4, v5
    v_cmp_gt_u32 vcc, 46080, v5
    s_mov_b64 s[30:31], vcc
    v_cmp_ne_u32 vcc, 9, v9
    s_and_b64 vcc, vcc, s[30:31]
    v_mov_b32 v35, 0x7fff0000
    s_nop 0
    v_cndmask_b32 v34, v35, v34, vcc
    s_mul_i32 s39, s20, 12
    s_add_u32 s39, s39, s22
    s_cmp_ge_u32 s39, 296
    s_cselect_b32 s40, 0, 1
    s_cmp_ge_u32 s39, 152
    s_cselect_b32 s41, 1, 0
    s_cselect_b32 s42, 152, 0
    s_sub_u32 s39, s39, s42
    s_lshl_b32 s39, s39, 2
    s_cmp_eq_u32 s40, 0
    s_cbranch_scc1 mega_wb11_nl
    v_add_u32 v8, s39, v4
    s_cmp_eq_u32 s41, 1
    s_cbranch_scc1 mega_wb11_k2
    v_and_b32 v12, 31, v8
    v_and_b32 v13, 0x13, v12
    v_and_b32 v14, 4, v12
    v_lshl_or_b32 v13, v14, 1, v13
    v_and_b32 v14, 8, v12
    v_lshrrev_b32 v14, 1, v14
    v_or_b32 v13, v13, v14
    v_lshrrev_b32 v12, 5, v8
    v_mov_b32 v14, 0
    v_mov_b32 v15, 0
    v_mov_b32 v16, 6
    v_cmp_le_u32 vcc, 7, v12
    s_nop 1
    v_cndmask_b32 v14, v14, 12, vcc
    v_cndmask_b32 v15, v15, 7, vcc
    v_cndmask_b32 v16, v16, 5, vcc
    v_cmp_le_u32 vcc, 13, v12
    s_nop 1
    v_cndmask_b32 v14, v14, 22, vcc
    v_cndmask_b32 v15, v15, 13, vcc
    v_sub_u32 v12, v12, v15
    v_lshrrev_b32 v15, 3, v13
    v_and_b32 v13, 7, v13
    v_lshl_add_u32 v10, v12, 1, v14
    v_lshrrev_b32 v17, 2, v13
    v_add_u32 v10, v10, v17
    v_mul_u32_u24 v10, 18, v10
    v_lshl_add_u32 v10, v15, 2, v10
    v_and_b32 v17, 3, v13
    v_add_u32 v10, v10, v17
    v_cmp_eq_u32 vcc, v12, v16
    v_lshrrev_b32 v12, 1, v13
    v_lshl_add_u32 v12, v12, 2, v15
    v_lshlrev_b32 v16, 1, v16
    v_add_u32 v14, v14, v12
    v_mul_u32_u24 v14, 18, v14
    v_and_b32 v13, 1, v13
    v_add_u32 v14, v14, v13
    v_add_u32 v14, 16, v14
    v_cndmask_b32 v10, v10, v14, vcc
    s_mov_b64 s[50:51], vcc
    v_cmp_ge_u32 vcc, v12, v16
    s_and_b64 vcc, vcc, s[50:51]
    v_mov_b32 v13, 0x100000
    s_nop 1
    v_cndmask_b32 v10, v10, v13, vcc
    s_mov_b32 s8, s64
    s_mov_b32 s9, s65
    s_mov_b32 s10, 0xa2000
    s_mov_b32 s11, 0x20000
    s_branch mega_wb11_k3
mega_wb11_k2:
    v_and_b32 v12, 31, v8
    v_and_b32 v13, 0x13, v12
    v_and_b32 v14, 4, v12
    v_lshl_or_b32 v13, v14, 1, v13
    v_and_b32 v14, 8, v12
    v_lshrrev_b32 v14, 1, v14
    v_or_b32 v13, v13, v14
    v_lshrrev_b32 v12, 5, v8
    v_lshl_add_u32 v10, v12, 5, v13
    s_mov_b32 s8, s68
    s_mov_b32 s9, s69
    s_mov_b32 s10, 0xa2000
    s_mov_b32 s11, 0x20000
mega_wb11_k3:
    v_mul_u32_u24 v11, 1152, v10
    v_lshl_add_u32 v11, v3, 4, v11
    buffer_load_dwordx4 v[100:103], v11, s[8:11], 0 offen offset:0
    buffer_load_dwordx4 v[104:107], v11, s[8:11], 0 offen offset:256
    buffer_load_dwordx4 v[108:111], v11, s[8:11], 0 offen offset:512
    buffer_load_dwordx4 v[112:115], v11, s[8:11], 0 offen offset:768
    v_mov_b32 v116, 0
    v_mov_b32 v117, 0
    v_mov_b32 v118, 0
    v_mov_b32 v119, 0
    s_mov_b32 exec_lo, 0xff00ff
    s_mov_b32 exec_hi, 0xff00ff
    buffer_load_dwordx4 v[116:119], v11, s[8:11], 0 offen offset:1024
    s_mov_b64 exec, -1
mega_wb11_nl:
    s_waitcnt vmcnt(0)
    s_add_u32 s12, s4, 0x28e0000
    s_addc_u32 s13, s5, 0
    s_mov_b32 s14, 0xbe000
    s_mov_b32 s15, 0x20000
    buffer_store_dwordx4 v[20:23], v32, s[12:15], 0 offen sc1
    s_add_u32 s12, s4, 0x29a0000
    s_addc_u32 s13, s5, 0
    s_mov_b32 s14, 0xb4000
    s_mov_b32 s15, 0x20000
    buffer_store_dwordx4 v[24:27], v33, s[12:15], 0 offen sc1
    s_add_u32 s12, s4, 0x2a60000
    s_addc_u32 s13, s5, 0
    s_mov_b32 s14, 0xb4000
    s_mov_b32 s15, 0x20000
    buffer_store_dwordx4 v[28:31], v34, s[12:15], 0 offen sc1
    s_cmp_eq_u32 s40, 0
    s_cbranch_scc1 mega_wb11
    s_mov_b32 s24, 0x3f803f80
    v_mov_b32 v120, 0
    v_dot2_f32_bf16 v120, v100, s24, v120
    v_dot2_f32_bf16 v120, v101, s24, v120
    v_dot2_f32_bf16 v120, v102, s24, v120
    v_dot2_f32_bf16 v120, v103, s24, v120
    v_dot2_f32_bf16 v120, v104, s24, v120
    v_dot2_f32_bf16 v120, v105, s24, v120
    v_dot2_f32_bf16 v120, v106, s24, v120
    v_dot2_f32_bf16 v120, v107, s24, v120
    v_dot2_f32_bf16 v120, v108, s24, v120
    v_dot2_f32_bf16 v120, v109, s24, v120
    v_dot2_f32_bf16 v120, v110, s24, v120
    v_dot2_f32_bf16 v120, v111, s24, v120
    v_dot2_f32_bf16 v120, v112, s24, v120
    v_dot2_f32_bf16 v120, v113, s24, v120
    v_dot2_f32_bf16 v120, v114, s24, v120
    v_dot2_f32_bf16 v120, v115, s24, v120
    v_dot2_f32_bf16 v120, v116, s24, v120
    v_dot2_f32_bf16 v120, v117, s24, v120
    v_dot2_f32_bf16 v120, v118, s24, v120
    v_dot2_f32_bf16 v120, v119, s24, v120
    s_nop 3
    v_add_f32_dpp v120, v120, v120 row_ror:8 row_mask:0xf bank_mask:0xf
    s_nop 1
    v_add_f32_dpp v120, v120, v120 row_ror:4 row_mask:0xf bank_mask:0xf
    s_nop 1
    v_add_f32_dpp v120, v120, v120 row_ror:2 row_mask:0xf bank_mask:0xf
    s_nop 1
    v_add_f32_dpp v120, v120, v120 row_ror:1 row_mask:0xf bank_mask:0xf
    s_nop 1
    v_mul_f32 v120, 0x3ae38e39, v120
    v_cvt_pk_bf16_f32 v121, v120, v120
    v_lshlrev_b32 v122, 16, v121
    v_sub_f32 v122, v120, v122
    v_and_b32 v121, 0xffff, v121
    v_cvt_pk_bf16_f32 v122, v122, v122
    v_lshl_or_b32 v124, v122, 16, v121
    v_mov_b32 v125, 0
    v_mov_b32 v126, 0
    v_mov_b32 v127, 0
    s_mov_b32 s42, 97280
    s_cmp_eq_u32 s41, 1
    s_cselect_b32 s42, 92160, s42
    v_mul_u32_u24 v12, 160, v8
    v_mul_lo_u32 v13, v3, s42
    v_add_u32 v12, v12, v13
    v_add_u32 v12, 144, v12
    s_cbranch_scc1 mega_wb11_s2
    s_add_u32 s12, s4, 0x28e0000
    s_addc_u32 s13, s5, 0
    s_mov_b32 s14, 0xbe000
    s_mov_b32 s15, 0x20000
    s_branch mega_wb11_s3
mega_wb11_s2:
    s_add_u32 s12, s4, 0x2a60000
    s_addc_u32 s13, s5, 0
    s_mov_b32 s14, 0xb4000
    s_mov_b32 s15, 0x20000
mega_wb11_s3:
    s_mov_b32 exec_lo, 0xff00ff
    s_mov_b32 exec_hi, 0xff00ff
    buffer_store_dwordx4 v[124:127], v12, s[12:15], 0 offen sc1
    s_mov_b64 exec, -1
mega_wb11:
    s_waitcnt vmcnt(0)
    s_barrier
    s_cmp_lg_u32 s22, 0
    s_cbranch_scc1 mega_hi12
    s_and_b32 s82, s20, 7
    s_add_u32 s82, s82, 152
    s_lshl_b32 s82, s82, 7
    v_mov_b32 v8, s82
    v_mov_b32 v6, 1
    s_mov_b64 exec, 1
    buffer_atomic_add v6, v8, s[84:87], 0 offen sc1
    s_mov_b64 exec, -1
mega_hi12:
    s_waitcnt vmcnt(0)
    v_add_u32 v6, s34, v59
    ds_read_b64_tr_b16 v[64:65], v6 offset:0
    ds_read_b64_tr_b16 v[66:67], v6 offset:2304
    ds_read_b64_tr_b16 v[68:69], v6 offset:32
    ds_read_b64_tr_b16 v[70:71], v6 offset:2336
    ds_read_b64_tr_b16 v[72:73], v6 offset:64
    ds_read_b64_tr_b16 v[74:75], v6 offset:2368
    ds_read_b64_tr_b16 v[76:77], v6 offset:96
    ds_read_b64_tr_b16 v[78:79], v6 offset:2400
    ds_read_b64_tr_b16 v[80:81], v6 offset:128
    ds_read_b64_tr_b16 v[82:83], v6 offset:2432
    ds_read_b64_tr_b16 v[84:85], v6 offset:160
    ds_read_b64_tr_b16 v[86:87], v6 offset:2464
    ds_read_b64_tr_b16 v[88:89], v6 offset:192
    ds_read_b64_tr_b16 v[90:91], v6 offset:2496
    ds_read_b64_tr_b16 v[92:93], v6 offset:224
    ds_read_b64_tr_b16 v[94:95], v6 offset:2528
    ds_read_b64_tr_b16 v[96:97], v6 offset:256
    ds_read_b64_tr_b16 v[98:99], v6 offset:2560
    s_waitcnt lgkmcnt(0)
    s_add_u32 s33, s36, 0
    buffer_store_dwordx4 v[64:67], v2, s[16:19], s33 offen offset:0 sc1
    buffer_store_dwordx4 v[68:71], v2, s[16:19], s33 offen offset:1024 sc1
    buffer_store_dwordx4 v[72:75], v2, s[16:19], s33 offen offset:2048 sc1
    s_add_u32 s33, s36, 110592
    buffer_store_dwordx4 v[76:79], v2, s[16:19], s33 offen offset:0 sc1
    buffer_store_dwordx4 v[80:83], v2, s[16:19], s33 offen offset:1024 sc1
    buffer_store_dwordx4 v[84:87], v2, s[16:19], s33 offen offset:2048 sc1
    s_add_u32 s33, s36, 221184
    buffer_store_dwordx4 v[88:91], v2, s[16:19], s33 offen offset:0 sc1
    buffer_store_dwordx4 v[92:95], v2, s[16:19], s33 offen offset:1024 sc1
    buffer_store_dwordx4 v[96:99], v2, s[16:19], s33 offen offset:2048 sc1
    s_waitcnt vmcnt(0)
    s_barrier
    s_cmp_lg_u32 s22, 0
    s_cbranch_scc1 mega_ha13
    s_add_u32 s82, s21, 144
    s_lshl_b32 s82, s82, 7
    v_mov_b32 v7, s82
    v_mov_b32 v6, 1
    s_mov_b64 exec, 1
    buffer_atomic_add v6, v7, s[84:87], 0 offen sc1
    s_mov_b64 exec, -1
mega_ha13:
    s_cmp_lg_u32 s22, 0
    s_cbranch_scc1 mega_ag14
    v_mov_b32 v5, 16384
    v_mov_b32 v6, 1
    s_mov_b64 exec, 1
    buffer_atomic_add v6, v5, s[84:87], 0 offen sc0 sc1
    s_waitcnt vmcnt(0)
    v_readfirstlane_b32 s82, v6
    s_cmp_lg_u32 s82, 255
    s_cbranch_scc1 mega_ag14_n
    v_mov_b32 v5, 16512
    v_mov_b32 v6, 1
    buffer_store_dword v6, v5, s[84:87], 0 offen sc1
mega_ag14_n:
    s_mov_b64 exec, -1
mega_ag14:
mega_PA2_j:
    v_and_b32 v1, 63, v0
    v_lshlrev_b32 v2, 4, v1
    v_and_b32 v3, 15, v1
    v_lshrrev_b32 v4, 4, v1
    s_and_b32 s20, s2, 7
    s_lshr_b32 s21, s2, 3
    s_lshl_b32 s20, s20, 2
    s_and_b32 s23, s21, 3
    s_add_u32 s20, s20, s23
    s_lshr_b32 s21, s21, 2
    s_and_b32 s24, s22, 3
    s_lshr_b32 s25, s22, 2
    s_lshl_b32 s26, s20, 2
    s_add_u32 s26, s26, s24
    s_lshl_b32 s30, s26, 4
    s_mov_b32 s33, 152
    s_cmp_lg_u32 s22, 0
    s_cbranch_scc1 mega_wc16
    v_and_b32 v1, 63, v0
    v_add_u32 v2, s33, v1
    v_lshlrev_b32 v1, 7, v2
    s_mov_b32 exec_lo, 0xff
    s_mov_b32 exec_hi, 0x0
    s_mov_b32 s82, 0
mega_pl17:
    buffer_load_dword v2, v1, s[84:87], 0 offen sc1
    s_waitcnt vmcnt(0)
    v_cmp_gt_u32 vcc, 8, v2
    s_add_u32 s82, s82, 1
    s_cmp_gt_u32 s82, 400000
    s_cbranch_scc1 mega_pl17_x
    s_cbranch_vccz mega_pl17_x
    s_sleep 1
    s_branch mega_pl17
mega_pl17_x:
    s_mov_b64 exec, -1
mega_wc16:
    s_barrier
    v_and_b32 v1, 63, v0
    v_lshlrev_b32 v2, 4, v1
    v_and_b32 v3, 15, v1
    v_lshrrev_b32 v4, 4, v1
    s_add_u32 s12, s4, 0x28e0000
    s_addc_u32 s13, s5, 0
    s_mov_b32 s14, 0xbe000
    s_mov_b32 s15, 0x20000
    s_mul_i32 s40, s21, 97280
    s_lshl_b32 s41, s22, 10
    s_add_u32 s42, s41, 0
    s_mov_b32 m0, s42
    s_add_u32 s43, s40, s42
    buffer_load_dwordx4 v2, s[12:15], s43 offen lds
    s_add_u32 s42, s41, 12288
    s_mov_b32 m0, s42
    s_add_u32 s43, s40, s42
    buffer_load_dwordx4 v2, s[12:15], s43 offen lds
    s_add_u32 s42, s41, 24576
    s_mov_b32 m0, s42
    s_add_u32 s43, s40, s42
    buffer_load_dwordx4 v2, s[12:15], s43 offen lds
    s_add_u32 s42, s41, 36864
    s_mov_b32 m0, s42
    s_add_u32 s43, s40, s42
    buffer_load_dwordx4 v2, s[12:15], s43 offen lds
    s_add_u32 s42, s41, 49152
    s_mov_b32 m0, s42
    s_add_u32 s43, s40, s42
    buffer_load_dwordx4 v2, s[12:15], s43 offen lds
    s_add_u32 s42, s41, 61440
    s_mov_b32 m0, s42
    s_add_u32 s43, s40, s42
    buffer_load_dwordx4 v2, s[12:15], s43 offen lds
    s_add_u32 s42, s41, 73728
    s_mov_b32 m0, s42
    s_add_u32 s43, s40, s42
    buffer_load_dwordx4 v2, s[12:15], s43 offen lds
    s_add_u32 s42, s41, 86016
    s_cmp_ge_u32 s42, 97280
    s_cselect_b32 s43, 12288, 0
    s_sub_u32 s42, s42, s43
    s_mov_b32 m0, s42
    s_add_u32 s43, s40, s42
    buffer_load_dwordx4 v2, s[12:15], s43 offen lds
    v_and_b32 v110, 1, v4
    v_lshlrev_b32 v7, 9, v110
    v_lshrrev_b32 v110, 1, v4
    v_lshl_add_u32 v7, v110, 8, v7
    v_lshl_add_u32 v7, v3, 4, v7
    v_and_b32 v110, 1, v4
    v_lshlrev_b32 v111, 5, v110
    v_lshrrev_b32 v110, 1, v4
    v_lshl_add_u32 v111, v110, 4, v111
    v_add_u32 v110, s30, v3
    v_mul_u32_u24 v112, 1152, v110
    v_add_u32 v112, v112, v111
    s_mul_i32 s35, s21, 144
    s_lshl_b32 s33, s25, 6
    s_add_u32 s35, s35, s33
    s_mov_b32 s16, s60
    s_mov_b32 s17, s61
    s_mov_b32 s18, 0x240000
    s_mov_b32 s19, 0x20000
    buffer_load_dwordx4 v[148:151], v112, s[16:19], s35 offen
    s_mov_b32 s27, 0
    s_mov_b32 s28, 0
    s_cmp_eq_u32 s25, 1
    s_cselect_b32 s27, 12, s27
    s_cselect_b32 s28, 7, s28
    s_cmp_eq_u32 s25, 2
    s_cselect_b32 s27, 22, s27
    s_cselect_b32 s28, 13, s28
    v_mul_u32_u24 v5, 48, v3
    v_lshl_add_u32 v5, v4, 4, v5
    v_mov_b32 v110, 912
    v_cmp_gt_u32 vcc, 3, v4
    s_mov_b64 s[36:37], vcc
    s_mul_i32 s38, s27, 960
    v_cndmask_b32 v5, v110, v5, vcc
    s_add_u32 s38, s38, 97280
    v_add_u32 v5, s38, v5
    v_and_b32 v111, 3, v3
    v_lshrrev_b32 v112, 2, v3
    v_mov_b32 v153, 19
    v_add_u32 v113, 16, v111
    v_cmp_eq_u32 vcc, 0, v112
    s_mov_b64 s[40:41], vcc
    v_cmp_gt_u32 vcc, 2, v111
    s_and_b64 vcc, vcc, s[40:41]
    s_nop 1
    v_cndmask_b32 v153, v153, v113, vcc
    v_cmp_eq_u32 vcc, 2, v111
    s_nop 1
    v_cndmask_b32 v153, v153, 18, vcc
    v_mul_u32_u24 v153, 48, v153
    v_lshl_add_u32 v153, v4, 4, v153
    v_cndmask_b32 v153, v110, v153, s[36:37]
    v_add_u32 v153, s38, v153
    v_mov_b32 v154, 19
    v_add_u32 v113, 16, v111
    v_cmp_eq_u32 vcc, 1, v112
    s_mov_b64 s[40:41], vcc
    v_cmp_gt_u32 vcc, 2, v111
    s_and_b64 vcc, vcc, s[40:41]
    s_nop 1
    v_cndmask_b32 v154, v154, v113, vcc
    v_cmp_eq_u32 vcc, 2, v111
    s_nop 1
    v_cndmask_b32 v154, v154, 18, vcc
    v_mul_u32_u24 v154, 48, v154
    v_lshl_add_u32 v154, v4, 4, v154
    v_cndmask_b32 v154, v110, v154, s[36:37]
    v_add_u32 v154, s38, v154
    v_mov_b32 v155, 19
    v_add_u32 v113, 16, v111
    v_cmp_eq_u32 vcc, 2, v112
    s_mov_b64 s[40:41], vcc
    v_cmp_gt_u32 vcc, 2, v111
    s_and_b64 vcc, vcc, s[40:41]
    s_nop 1
    v_cndmask_b32 v155, v155, v113, vcc
    v_cmp_eq_u32 vcc, 2, v111
    s_nop 1
    v_cndmask_b32 v155, v155, 18, vcc
    v_mul_u32_u24 v155, 48, v155
    v_lshl_add_u32 v155, v4, 4, v155
    v_cndmask_b32 v155, v110, v155, s[36:37]
    v_add_u32 v155, s38, v155
    v_mov_b32 v156, 19
    v_add_u32 v113, 16, v111
    v_cmp_eq_u32 vcc, 3, v112
    s_mov_b64 s[40:41], vcc
    v_cmp_gt_u32 vcc, 2, v111
    s_and_b64 vcc, vcc, s[40:41]
    s_nop 1
    v_cndmask_b32 v156, v156, v113, vcc
    v_cmp_eq_u32 vcc, 2, v111
    s_nop 1
    v_cndmask_b32 v156, v156, 18, vcc
    v_mul_u32_u24 v156, 48, v156
    v_lshl_add_u32 v156, v4, 4, v156
    v_cndmask_b32 v156, v110, v156, s[36:37]
    v_add_u32 v156, s38, v156
    v_lshrrev_b32 v6, 5, v1
    v_lshlrev_b32 v6, 4, v6
    v_bfe_u32 v110, v1, 4, 1
    v_lshl_add_u32 v6, v110, 2, v6
    v_bfe_u32 v110, v1, 2, 2
    v_add_u32 v6, v6, v110
    v_mul_u32_u24 v6, 160, v6
    v_and_b32 v110, 3, v1
    v_lshl_add_u32 v6, v110, 3, v6
    s_mul_i32 s31, s28, 5120
    v_add_u32 v6, s31, v6
    v_mov_b32 v144, 0
    v_mov_b32 v145, 0
    v_mov_b32 v146, 0x358637bd
    v_mov_b32 v147, 0
    v_mov_b32 v100, 0
    v_mov_b32 v101, 0
    v_mov_b32 v102, 0
    v_mov_b32 v103, 0
    v_mov_b32 v124, 0
    v_mov_b32 v125, 0
    v_mov_b32 v126, 0
    v_mov_b32 v127, 0
    v_mov_b32 v128, 0
    v_mov_b32 v129, 0
    v_mov_b32 v130, 0
    v_mov_b32 v131, 0
    v_mov_b32 v132, 0
    v_mov_b32 v133, 0
    v_mov_b32 v134, 0
    v_mov_b32 v135, 0
    v_mov_b32 v136, 0
    v_mov_b32 v137, 0
    v_mov_b32 v138, 0
    v_mov_b32 v139, 0
    v_mov_b32 v140, 0
    v_mov_b32 v141, 0
    v_mov_b32 v142, 0
    v_mov_b32 v143, 0
    s_add_u32 s44, s4, 0x20e0000
    s_addc_u32 s45, s5, 0
    s_mov_b32 s46, 0x240000
    s_mov_b32 s47, 0x20000
    s_add_u32 s48, s4, 0x2360000
    s_addc_u32 s49, s5, 0
    s_mov_b32 s50, 0x2000
    s_mov_b32 s51, 0x20000
    s_add_u32 s52, s4, 0x2320000
    s_addc_u32 s53, s5, 0
    s_mov_b32 s54, 0x40000
    s_mov_b32 s55, 0x20000
    s_add_u32 s8, s4, 0x28c0000
    s_addc_u32 s9, s5, 0
    s_mov_b32 s10, 0xf000
    s_mov_b32 s11, 0x20000
    s_add_u32 s16, s4, 0x25c0000
    s_addc_u32 s17, s5, 0
    s_mov_b32 s18, 0x300000
    s_mov_b32 s19, 0x20000
    s_lshl_b32 s34, s26, 5
    s_add_u32 s34, s34, s27
    s_mul_i32 s34, s34, 768
    v_lshlrev_b32 v157, 4, v0
    v_lshlrev_b32 v158, 3, v0
    v_add_u32 v158, 97280, v158
    s_mov_b32 s33, 129
    v_mov_b32 v159, v1
    v_mov_b32 v160, v2
    s_cmp_lg_u32 s22, 0
    s_cbranch_scc1 mega_wc18
    v_and_b32 v1, 63, v0
    v_add_u32 v2, s33, v1
    v_lshlrev_b32 v1, 7, v2
    s_mov_b32 exec_lo, 0x1
    s_mov_b32 exec_hi, 0x0
    s_mov_b32 s82, 0
mega_pl19:
    buffer_load_dword v2, v1, s[84:87], 0 offen sc1
    s_waitcnt vmcnt(0)
    v_cmp_gt_u32 vcc, 1, v2
    s_add_u32 s82, s82, 1
    s_cmp_gt_u32 s82, 400000
    s_cbranch_scc1 mega_pl19_x
    s_cbranch_vccz mega_pl19_x
    s_sleep 1
    s_branch mega_pl19
mega_pl19_x:
    s_mov_b64 exec, -1
mega_wc18:
    s_barrier
    v_mov_b32 v1, v159
    v_mov_b32 v2, v160
    buffer_load_dwordx4 v[56:59], v157, s[8:11], 0 offen sc1
    v_add_u32 v157, 12288, v157
    buffer_load_dwordx4 v[60:63], v157, s[8:11], 0 offen sc1
    v_add_u32 v157, 12288, v157
    buffer_load_dwordx4 v[64:67], v157, s[8:11], 0 offen sc1
    v_add_u32 v157, 12288, v157
    buffer_load_dwordx4 v[68:71], v157, s[8:11], 0 offen sc1
    v_add_u32 v157, 12288, v157
    buffer_load_dwordx4 v[72:75], v157, s[8:11], 0 offen sc1
    s_barrier
    buffer_load_dwordx4 v[8:11], v2, s[16:19], s34 offen offset:0 sc1
    buffer_load_dwordx4 v[12:15], v2, s[16:19], s34 offen offset:768 sc1
    buffer_load_dwordx4 v[16:19], v2, s[16:19], s34 offen offset:1536 sc1
    buffer_load_dwordx4 v[20:23], v2, s[16:19], s34 offen offset:2304 sc1
    buffer_load_dwordx4 v[24:27], v2, s[16:19], s34 offen offset:3072 sc1
    s_add_u32 s34, s34, 3840
    buffer_load_dwordx4 v[28:31], v2, s[16:19], s34 offen offset:0 sc1
    buffer_load_dwordx4 v[32:35], v2, s[16:19], s34 offen offset:768 sc1
    buffer_load_dwordx4 v[36:39], v2, s[16:19], s34 offen offset:1536 sc1
    buffer_load_dwordx4 v[40:43], v2, s[16:19], s34 offen offset:2304 sc1
    buffer_load_dwordx4 v[44:47], v2, s[16:19], s34 offen offset:3072 sc1
    s_add_u32 s34, s34, 3840
    buffer_load_dwordx4 v[48:51], v2, s[16:19], s34 offen offset:0 sc1
    buffer_load_dwordx4 v[52:55], v2, s[16:19], s34 offen offset:768 sc1
    s_add_u32 s16, s4, 0x28d0000
    s_addc_u32 s17, s5, 0
    s_mov_b32 s18, 0x2000
    s_mov_b32 s19, 0x20000
    v_add_u32 v110, s30, v3
    v_lshlrev_b32 v110, 2, v110
    buffer_load_dword v152, v110, s[16:19], 0 offen sc1
    s_waitcnt vmcnt(17)
    v_cvt_pk_bf16_f32 v56, v56, v57
    v_cvt_pk_bf16_f32 v57, v58, v59
    ds_write_b64 v158, v[56:57] offset:0
    s_waitcnt vmcnt(16)
    v_cvt_pk_bf16_f32 v60, v60, v61
    v_cvt_pk_bf16_f32 v61, v62, v63
    ds_write_b64 v158, v[60:61] offset:6144
    s_waitcnt vmcnt(15)
    v_cvt_pk_bf16_f32 v64, v64, v65
    v_cvt_pk_bf16_f32 v65, v66, v67
    ds_write_b64 v158, v[64:65] offset:12288
    s_waitcnt vmcnt(14)
    v_cvt_pk_bf16_f32 v68, v68, v69
    v_cvt_pk_bf16_f32 v69, v70, v71
    ds_write_b64 v158, v[68:69] offset:18432
    s_waitcnt vmcnt(13)
    v_cvt_pk_bf16_f32 v72, v72, v73
    v_cvt_pk_bf16_f32 v73, v74, v75
    ds_write_b64 v158, v[72:73] offset:24576
    s_waitcnt lgkmcnt(0)
    s_barrier
    s_cmp_lg_u32 s25, 0
    s_cbranch_scc1 mega_B15_r10
    ds_read_b128 v[56:59], v5 offset:0
    ds_read_b128 v[60:63], v153 offset:0
    ds_read_b128 v[64:67], v5 offset:960
    ds_read_b128 v[68:71], v154 offset:960
    ds_read_b64_tr_b16 v[104:105], v6 offset:0
    ds_read_b64_tr_b16 v[106:107], v6 offset:1280
    ds_read_b64_tr_b16 v[108:109], v6 offset:32
    ds_read_b64_tr_b16 v[110:111], v6 offset:1312
    ds_read_b64_tr_b16 v[112:113], v6 offset:64
    ds_read_b64_tr_b16 v[114:115], v6 offset:1344
    ds_read_b64_tr_b16 v[116:117], v6 offset:96
    ds_read_b64_tr_b16 v[118:119], v6 offset:1376
    ds_read_b64_tr_b16 v[120:121], v6 offset:128
    ds_read_b64_tr_b16 v[122:123], v6 offset:1408
    s_waitcnt lgkmcnt(12)
    s_waitcnt vmcnt(12)
    v_mfma_f32_16x16x32_bf16 v[80:83], v[56:59], v[8:11], 0
    v_mfma_f32_16x16x32_bf16 v[84:87], v[60:63], v[8:11], v[144:147]
    s_waitcnt lgkmcnt(10)
    s_waitcnt vmcnt(11)
    v_mfma_f32_16x16x32_bf16 v[88:91], v[64:67], v[12:15], 0
    v_mfma_f32_16x16x32_bf16 v[92:95], v[68:71], v[12:15], v[144:147]
    ds_read_b128 v[72:75], v5 offset:1920
    ds_read_b128 v[76:79], v155 offset:1920
    s_nop 3
    v_rcp_f32 v86, v86
    s_nop 0
    v_mul_f32 v80, v80, v86
    v_mul_f32 v81, v81, v86
    v_mul_f32 v82, v82, v86
    v_mul_f32 v83, v83, v86
    v_mul_f32 v84, v84, v86
    v_mul_f32 v85, v85, v86
    v_cvt_pk_bf16_f32 v96, v80, v81
    v_cvt_pk_bf16_f32 v97, v82, v83
    v_cvt_pk_bf16_f32 v84, v84, v85
    v_or_b32 v100, v100, v84
    ds_read_b128 v[56:59], v5 offset:2880
    ds_read_b128 v[60:63], v156 offset:2880
    s_nop 1
    v_rcp_f32 v94, v94
    s_nop 0
    v_mul_f32 v88, v88, v94
    v_mul_f32 v89, v89, v94
    v_mul_f32 v90, v90, v94
    v_mul_f32 v91, v91, v94
    v_mul_f32 v92, v92, v94
    v_mul_f32 v93, v93, v94
    v_cvt_pk_bf16_f32 v98, v88, v89
    v_cvt_pk_bf16_f32 v99, v90, v91
    v_cvt_pk_bf16_f32 v92, v92, v93
    v_or_b32 v100, v100, v92
    s_waitcnt lgkmcnt(4)
    s_nop 0
    v_mfma_f32_16x16x32_bf16 v[124:127], v[104:107], v[96:99], v[124:127]
    v_mfma_f32_16x16x32_bf16 v[128:131], v[108:111], v[96:99], v[128:131]
    v_mfma_f32_16x16x32_bf16 v[132:135], v[112:115], v[96:99], v[132:135]
    v_mfma_f32_16x16x32_bf16 v[136:139], v[116:119], v[96:99], v[136:139]
    v_mfma_f32_16x16x32_bf16 v[140:143], v[120:123], v[96:99], v[140:143]
    ds_read_b64_tr_b16 v[104:105], v6 offset:5120
    ds_read_b64_tr_b16 v[106:107], v6 offset:6400
    ds_read_b64_tr_b16 v[108:109], v6 offset:5152
    ds_read_b64_tr_b16 v[110:111], v6 offset:6432
    ds_read_b64_tr_b16 v[112:113], v6 offset:5184
    ds_read_b64_tr_b16 v[114:115], v6 offset:6464
    ds_read_b64_tr_b16 v[116:117], v6 offset:5216
    ds_read_b64_tr_b16 v[118:119], v6 offset:6496
    ds_read_b64_tr_b16 v[120:121], v6 offset:5248
    ds_read_b64_tr_b16 v[122:123], v6 offset:6528
    s_waitcnt lgkmcnt(12)
    s_waitcnt vmcnt(10)
    v_mfma_f32_16x16x32_bf16 v[80:83], v[72:75], v[16:19], 0
    v_mfma_f32_16x16x32_bf16 v[84:87], v[76:79], v[16:19], v[144:147]
    s_waitcnt lgkmcnt(10)
    s_waitcnt vmcnt(9)
    v_mfma_f32_16x16x32_bf16 v[88:91], v[56:59], v[20:23], 0
    v_mfma_f32_16x16x32_bf16 v[92:95], v[60:63], v[20:23], v[144:147]
    ds_read_b128 v[64:67], v5 offset:3840
    ds_read_b128 v[68:71], v153 offset:3840
    s_nop 3
    v_rcp_f32 v86, v86
    s_nop 0
    v_mul_f32 v80, v80, v86
    v_mul_f32 v81, v81, v86
    v_mul_f32 v82, v82, v86
    v_mul_f32 v83, v83, v86
    v_mul_f32 v84, v84, v86
    v_mul_f32 v85, v85, v86
    v_cvt_pk_bf16_f32 v96, v80, v81
    v_cvt_pk_bf16_f32 v97, v82, v83
    v_cvt_pk_bf16_f32 v84, v84, v85
    v_or_b32 v100, v100, v84
    ds_read_b128 v[72:75], v5 offset:4800
    ds_read_b128 v[76:79], v154 offset:4800
    s_nop 1
    v_rcp_f32 v94, v94
    s_nop 0
    v_mul_f32 v88, v88, v94
    v_mul_f32 v89, v89, v94
    v_mul_f32 v90, v90, v94
    v_mul_f32 v91, v91, v94
    v_mul_f32 v92, v92, v94
    v_mul_f32 v93, v93, v94
    v_cvt_pk_bf16_f32 v98, v88, v89
    v_cvt_pk_bf16_f32 v99, v90, v91
    v_cvt_pk_bf16_f32 v92, v92, v93
    v_or_b32 v100, v100, v92
    s_waitcnt lgkmcnt(4)
    s_nop 0
    v_mfma_f32_16x16x32_bf16 v[124:127], v[104:107], v[96:99], v[124:127]
    v_mfma_f32_16x16x32_bf16 v[128:131], v[108:111], v[96:99], v[128:131]
    v_mfma_f32_16x16x32_bf16 v[132:135], v[112:115], v[96:99], v[132:135]
    v_mfma_f32_16x16x32_bf16 v[136:139], v[116:119], v[96:99], v[136:139]
    v_mfma_f32_16x16x32_bf16 v[140:143], v[120:123], v[96:99], v[140:143]
    ds_read_b64_tr_b16 v[104:105], v6 offset:10240
    ds_read_b64_tr_b16 v[106:107], v6 offset:11520
    ds_read_b64_tr_b16 v[108:109], v6 offset:10272
    ds_read_b64_tr_b16 v[110:111], v6 offset:11552
    ds_read_b64_tr_b16 v[112:113], v6 offset:10304
    ds_read_b64_tr_b16 v[114:115], v6 offset:11584
    ds_read_b64_tr_b16 v[116:117], v6 offset:10336
    ds_read_b64_tr_b16 v[118:119], v6 offset:11616
    ds_read_b64_tr_b16 v[120:121], v6 offset:10368
    ds_read_b64_tr_b16 v[122:123], v6 offset:11648
    s_waitcnt lgkmcnt(12)
    s_waitcnt vmcnt(8)
    v_mfma_f32_16x16x32_bf16 v[80:83], v[64:67], v[24:27], 0
    v_mfma_f32_16x16x32_bf16 v[84:87], v[68:71], v[24:27], v[144:147]
    s_waitcnt lgkmcnt(10)
    s_waitcnt vmcnt(7)
    v_mfma_f32_16x16x32_bf16 v[88:91], v[72:75], v[28:31], 0
    v_mfma_f32_16x16x32_bf16 v[92:95], v[76:79], v[28:31], v[144:147]
    ds_read_b128 v[56:59], v5 offset:5760
    ds_read_b128 v[60:63], v155 offset:5760
    s_nop 3
    v_rcp_f32 v86, v86
    s_nop 0
    v_mul_f32 v80, v80, v86
    v_mul_f32 v81, v81, v86
    v_mul_f32 v82, v82, v86
    v_mul_f32 v83, v83, v86
    v_mul_f32 v84, v84, v86
    v_mul_f32 v85, v85, v86
    v_cvt_pk_bf16_f32 v96, v80, v81
    v_cvt_pk_bf16_f32 v97, v82, v83
    v_cvt_pk_bf16_f32 v84, v84, v85
    v_or_b32 v101, v101, v84
    ds_read_b128 v[64:67], v5 offset:6720
    ds_read_b128 v[68:71], v156 offset:6720
    s_nop 1
    v_rcp_f32 v94, v94
    s_nop 0
    v_mul_f32 v88, v88, v94
    v_mul_f32 v89, v89, v94
    v_mul_f32 v90, v90, v94
    v_mul_f32 v91, v91, v94
    v_mul_f32 v92, v92, v94
    v_mul_f32 v93, v93, v94
    v_cvt_pk_bf16_f32 v98, v88, v89
    v_cvt_pk_bf16_f32 v99, v90, v91
    v_cvt_pk_bf16_f32 v92, v92, v93
    v_or_b32 v101, v101, v92
    s_waitcnt lgkmcnt(4)
    s_nop 0
    v_mfma_f32_16x16x32_bf16 v[124:127], v[104:107], v[96:99], v[124:127]
    v_mfma_f32_16x16x32_bf16 v[128:131], v[108:111], v[96:99], v[128:131]
    v_mfma_f32_16x16x32_bf16 v[132:135], v[112:115], v[96:99], v[132:135]
    v_mfma_f32_16x16x32_bf16 v[136:139], v[116:119], v[96:99], v[136:139]
    v_mfma_f32_16x16x32_bf16 v[140:143], v[120:123], v[96:99], v[140:143]
    ds_read_b64_tr_b16 v[104:105], v6 offset:15360
    ds_read_b64_tr_b16 v[106:107], v6 offset:16640
    ds_read_b64_tr_b16 v[108:109], v6 offset:15392
    ds_read_b64_tr_b16 v[110:111], v6 offset:16672
    ds_read_b64_tr_b16 v[112:113], v6 offset:15424
    ds_read_b64_tr_b16 v[114:115], v6 offset:16704
    ds_read_b64_tr_b16 v[116:117], v6 offset:15456
    ds_read_b64_tr_b16 v[118:119], v6 offset:16736
    ds_read_b64_tr_b16 v[120:121], v6 offset:15488
    ds_read_b64_tr_b16 v[122:123], v6 offset:16768
    s_waitcnt lgkmcnt(12)
    s_waitcnt vmcnt(6)
    v_mfma_f32_16x16x32_bf16 v[80:83], v[56:59], v[32:35], 0
    v_mfma_f32_16x16x32_bf16 v[84:87], v[60:63], v[32:35], v[144:147]
    s_waitcnt lgkmcnt(10)
    s_waitcnt vmcnt(5)
    v_mfma_f32_16x16x32_bf16 v[88:91], v[64:67], v[36:39], 0
    v_mfma_f32_16x16x32_bf16 v[92:95], v[68:71], v[36:39], v[144:147]
    ds_read_b128 v[72:75], v5 offset:7680
    ds_read_b128 v[76:79], v153 offset:7680
    s_nop 3
    v_rcp_f32 v86, v86
    s_nop 0
    v_mul_f32 v80, v80, v86
    v_mul_f32 v81, v81, v86
    v_mul_f32 v82, v82, v86
    v_mul_f32 v83, v83, v86
    v_mul_f32 v84, v84, v86
    v_mul_f32 v85, v85, v86
    v_cvt_pk_bf16_f32 v96, v80, v81
    v_cvt_pk_bf16_f32 v97, v82, v83
    v_cvt_pk_bf16_f32 v84, v84, v85
    v_or_b32 v101, v101, v84
    ds_read_b128 v[56:59], v5 offset:8640
    ds_read_b128 v[60:63], v154 offset:8640
    s_nop 1
    v_rcp_f32 v94, v94
    s_nop 0
    v_mul_f32 v88, v88, v94
    v_mul_f32 v89, v89, v94
    v_mul_f32 v90, v90, v94
    v_mul_f32 v91, v91, v94
    v_mul_f32 v92, v92, v94
    v_mul_f32 v93, v93, v94
    v_cvt_pk_bf16_f32 v98, v88, v89
    v_cvt_pk_bf16_f32 v99, v90, v91
    v_cvt_pk_bf16_f32 v92, v92, v93
    v_or_b32 v101, v101, v92
    s_waitcnt lgkmcnt(4)
    s_nop 0
    v_mfma_f32_16x16x32_bf16 v[124:127], v[104:107], v[96:99], v[124:127]
    v_mfma_f32_16x16x32_bf16 v[128:131], v[108:111], v[96:99], v[128:131]
    v_mfma_f32_16x16x32_bf16 v[132:135], v[112:115], v[96:99], v[132:135]
    v_mfma_f32_16x16x32_bf16 v[136:139], v[116:119], v[96:99], v[136:139]
    v_mfma_f32_16x16x32_bf16 v[140:143], v[120:123], v[96:99], v[140:143]
    ds_read_b64_tr_b16 v[104:105], v6 offset:20480
    ds_read_b64_tr_b16 v[106:107], v6 offset:21760
    ds_read_b64_tr_b16 v[108:109], v6 offset:20512
    ds_read_b64_tr_b16 v[110:111], v6 offset:21792
    ds_read_b64_tr_b16 v[112:113], v6 offset:20544
    ds_read_b64_tr_b16 v[114:115], v6 offset:21824
    ds_read_b64_tr_b16 v[116:117], v6 offset:20576
    ds_read_b64_tr_b16 v[118:119], v6 offset:21856
    ds_read_b64_tr_b16 v[120:121], v6 offset:20608
    ds_read_b64_tr_b16 v[122:123], v6 offset:21888
    s_waitcnt lgkmcnt(12)
    s_waitcnt vmcnt(4)
    v_mfma_f32_16x16x32_bf16 v[80:83], v[72:75], v[40:43], 0
    v_mfma_f32_16x16x32_bf16 v[84:87], v[76:79], v[40:43], v[144:147]
    s_waitcnt lgkmcnt(10)
    s_waitcnt vmcnt(3)
    v_mfma_f32_16x16x32_bf16 v[88:91], v[56:59], v[44:47], 0
    v_mfma_f32_16x16x32_bf16 v[92:95], v[60:63], v[44:47], v[144:147]
    ds_read_b128 v[64:67], v5 offset:9600
    ds_read_b128 v[68:71], v155 offset:9600
    s_nop 3
    v_rcp_f32 v86, v86
    s_nop 0
    v_mul_f32 v80, v80, v86
    v_mul_f32 v81, v81, v86
    v_mul_f32 v82, v82, v86
    v_mul_f32 v83, v83, v86
    v_mul_f32 v84, v84, v86
    v_mul_f32 v85, v85, v86
    v_cvt_pk_bf16_f32 v96, v80, v81
    v_cvt_pk_bf16_f32 v97, v82, v83
    v_cvt_pk_bf16_f32 v84, v84, v85
    v_or_b32 v102, v102, v84
    ds_read_b128 v[72:75], v5 offset:10560
    ds_read_b128 v[76:79], v156 offset:10560
    s_nop 1
    v_rcp_f32 v94, v94
    s_nop 0
    v_mul_f32 v88, v88, v94
    v_mul_f32 v89, v89, v94
    v_mul_f32 v90, v90, v94
    v_mul_f32 v91, v91, v94
    v_mul_f32 v92, v92, v94
    v_mul_f32 v93, v93, v94
    v_cvt_pk_bf16_f32 v98, v88, v89
    v_cvt_pk_bf16_f32 v99, v90, v91
    v_cvt_pk_bf16_f32 v92, v92, v93
    v_or_b32 v102, v102, v92
    s_waitcnt lgkmcnt(4)
    s_nop 0
    v_mfma_f32_16x16x32_bf16 v[124:127], v[104:107], v[96:99], v[124:127]
    v_mfma_f32_16x16x32_bf16 v[128:131], v[108:111], v[96:99], v[128:131]
    v_mfma_f32_16x16x32_bf16 v[132:135], v[112:115], v[96:99], v[132:135]
    v_mfma_f32_16x16x32_bf16 v[136:139], v[116:119], v[96:99], v[136:139]
    v_mfma_f32_16x16x32_bf16 v[140:143], v[120:123], v[96:99], v[140:143]
    ds_read_b64_tr_b16 v[104:105], v6 offset:25600
    ds_read_b64_tr_b16 v[106:107], v6 offset:26880
    ds_read_b64_tr_b16 v[108:109], v6 offset:25632
    ds_read_b64_tr_b16 v[110:111], v6 offset:26912
    ds_read_b64_tr_b16 v[112:113], v6 offset:25664
    ds_read_b64_tr_b16 v[114:115], v6 offset:26944
    ds_read_b64_tr_b16 v[116:117], v6 offset:25696
    ds_read_b64_tr_b16 v[118:119], v6 offset:26976
    ds_read_b64_tr_b16 v[120:121], v6 offset:25728
    ds_read_b64_tr_b16 v[122:123], v6 offset:27008
    s_waitcnt lgkmcnt(12)
    s_waitcnt vmcnt(2)
    v_mfma_f32_16x16x32_bf16 v[80:83], v[64:67], v[48:51], 0
    v_mfma_f32_16x16x32_bf16 v[84:87], v[68:71], v[48:51], v[144:147]
    s_waitcnt lgkmcnt(10)
    s_waitcnt vmcnt(1)
    v_mfma_f32_16x16x32_bf16 v[88:91], v[72:75], v[52:55], 0
    v_mfma_f32_16x16x32_bf16 v[92:95], v[76:79], v[52:55], v[144:147]
    s_nop 3
    v_rcp_f32 v86, v86
    s_nop 0
    v_mul_f32 v80, v80, v86
    v_mul_f32 v81, v81, v86
    v_mul_f32 v82, v82, v86
    v_mul_f32 v83, v83, v86
    v_mul_f32 v84, v84, v86
    v_mul_f32 v85, v85, v86
    v_cvt_pk_bf16_f32 v96, v80, v81
    v_cvt_pk_bf16_f32 v97, v82, v83
    v_cvt_pk_bf16_f32 v84, v84, v85
    v_or_b32 v102, v102, v84
    s_nop 1
    v_rcp_f32 v94, v94
    s_nop 0
    v_mul_f32 v88, v88, v94
    v_mul_f32 v89, v89, v94
    v_mul_f32 v90, v90, v94
    v_mul_f32 v91, v91, v94
    v_mul_f32 v92, v92, v94
    v_mul_f32 v93, v93, v94
    v_cvt_pk_bf16_f32 v98, v88, v89
    v_cvt_pk_bf16_f32 v99, v90, v91
    v_cvt_pk_bf16_f32 v92, v92, v93
    v_or_b32 v102, v102, v92
    s_waitcnt lgkmcnt(0)
    s_nop 0
    v_mfma_f32_16x16x32_bf16 v[124:127], v[104:107], v[96:99], v[124:127]
    v_mfma_f32_16x16x32_bf16 v[128:131], v[108:111], v[96:99], v[128:131]
    v_mfma_f32_16x16x32_bf16 v[132:135], v[112:115], v[96:99], v[132:135]
    v_mfma_f32_16x16x32_bf16 v[136:139], v[116:119], v[96:99], v[136:139]
    v_mfma_f32_16x16x32_bf16 v[140:143], v[120:123], v[96:99], v[140:143]
    ds_read_b64_tr_b16 v[104:105], v6 offset:30720
    ds_read_b64_tr_b16 v[106:107], v6 offset:32000
    ds_read_b64_tr_b16 v[108:109], v6 offset:30752
    ds_read_b64_tr_b16 v[110:111], v6 offset:32032
    ds_read_b64_tr_b16 v[112:113], v6 offset:30784
    ds_read_b64_tr_b16 v[114:115], v6 offset:32064
    ds_read_b64_tr_b16 v[116:117], v6 offset:30816
    ds_read_b64_tr_b16 v[118:119], v6 offset:32096
    ds_read_b64_tr_b16 v[120:121], v6 offset:30848
    ds_read_b64_tr_b16 v[122:123], v6 offset:32128
    s_waitcnt lgkmcnt(0)
    v_mfma_f32_16x16x32_bf16 v[124:127], v[104:107], v[100:103], v[124:127]
    v_mfma_f32_16x16x32_bf16 v[128:131], v[108:111], v[100:103], v[128:131]
    v_mfma_f32_16x16x32_bf16 v[132:135], v[112:115], v[100:103], v[132:135]
    v_mfma_f32_16x16x32_bf16 v[136:139], v[116:119], v[100:103], v[136:139]
    v_mfma_f32_16x16x32_bf16 v[140:143], v[120:123], v[100:103], v[140:143]
    s_branch mega_B15_rj
mega_B15_r10:
    ds_read_b128 v[56:59], v5 offset:0
    ds_read_b128 v[60:63], v153 offset:0
    ds_read_b128 v[64:67], v5 offset:960
    ds_read_b128 v[68:71], v154 offset:960
    ds_read_b64_tr_b16 v[104:105], v6 offset:0
    ds_read_b64_tr_b16 v[106:107], v6 offset:1280
    ds_read_b64_tr_b16 v[108:109], v6 offset:32
    ds_read_b64_tr_b16 v[110:111], v6 offset:1312
    ds_read_b64_tr_b16 v[112:113], v6 offset:64
    ds_read_b64_tr_b16 v[114:115], v6 offset:1344
    ds_read_b64_tr_b16 v[116:117], v6 offset:96
    ds_read_b64_tr_b16 v[118:119], v6 offset:1376
    ds_read_b64_tr_b16 v[120:121], v6 offset:128
    ds_read_b64_tr_b16 v[122:123], v6 offset:1408
    s_waitcnt lgkmcnt(12)
    s_waitcnt vmcnt(12)
    v_mfma_f32_16x16x32_bf16 v[80:83], v[56:59], v[8:11], 0
    v_mfma_f32_16x16x32_bf16 v[84:87], v[60:63], v[8:11], v[144:147]
    s_waitcnt lgkmcnt(10)
    s_waitcnt vmcnt(11)
    v_mfma_f32_16x16x32_bf16 v[88:91], v[64:67], v[12:15], 0
    v_mfma_f32_16x16x32_bf16 v[92:95], v[68:71], v[12:15], v[144:147]
    ds_read_b128 v[72:75], v5 offset:1920
    ds_read_b128 v[76:79], v155 offset:1920
    s_nop 3
    v_rcp_f32 v86, v86
    s_nop 0
    v_mul_f32 v80, v80, v86
    v_mul_f32 v81, v81, v86
    v_mul_f32 v82, v82, v86
    v_mul_f32 v83, v83, v86
    v_mul_f32 v84, v84, v86
    v_mul_f32 v85, v85, v86
    v_cvt_pk_bf16_f32 v96, v80, v81
    v_cvt_pk_bf16_f32 v97, v82, v83
    v_cvt_pk_bf16_f32 v84, v84, v85
    v_or_b32 v100, v100, v84
    ds_read_b128 v[56:59], v5 offset:2880
    ds_read_b128 v[60:63], v156 offset:2880
    s_nop 1
    v_rcp_f32 v94, v94
    s_nop 0
    v_mul_f32 v88, v88, v94
    v_mul_f32 v89, v89, v94
    v_mul_f32 v90, v90, v94
    v_mul_f32 v91, v91, v94
    v_mul_f32 v92, v92, v94
    v_mul_f32 v93, v93, v94
    v_cvt_pk_bf16_f32 v98, v88, v89
    v_cvt_pk_bf16_f32 v99, v90, v91
    v_cvt_pk_bf16_f32 v92, v92, v93
    v_or_b32 v100, v100, v92
    s_waitcnt lgkmcnt(4)
    s_nop 0
    v_mfma_f32_16x16x32_bf16 v[124:127], v[104:107], v[96:99], v[124:127]
    v_mfma_f32_16x16x32_bf16 v[128:131], v[108:111], v[96:99], v[128:131]
    v_mfma_f32_16x16x32_bf16 v[132:135], v[112:115], v[96:99], v[132:135]
    v_mfma_f32_16x16x32_bf16 v[136:139], v[116:119], v[96:99], v[136:139]
    v_mfma_f32_16x16x32_bf16 v[140:143], v[120:123], v[96:99], v[140:143]
    ds_read_b64_tr_b16 v[104:105], v6 offset:5120
    ds_read_b64_tr_b16 v[106:107], v6 offset:6400
    ds_read_b64_tr_b16 v[108:109], v6 offset:5152
    ds_read_b64_tr_b16 v[110:111], v6 offset:6432
    ds_read_b64_tr_b16 v[112:113], v6 offset:5184
    ds_read_b64_tr_b16 v[114:115], v6 offset:6464
    ds_read_b64_tr_b16 v[116:117], v6 offset:5216
    ds_read_b64_tr_b16 v[118:119], v6 offset:6496
    ds_read_b64_tr_b16 v[120:121], v6 offset:5248
    ds_read_b64_tr_b16 v[122:123], v6 offset:6528
    s_waitcnt lgkmcnt(12)
    s_waitcnt vmcnt(10)
    v_mfma_f32_16x16x32_bf16 v[80:83], v[72:75], v[16:19], 0
    v_mfma_f32_16x16x32_bf16 v[84:87], v[76:79], v[16:19], v[144:147]
    s_waitcnt lgkmcnt(10)
    s_waitcnt vmcnt(9)
    v_mfma_f32_16x16x32_bf16 v[88:91], v[56:59], v[20:23], 0
    v_mfma_f32_16x16x32_bf16 v[92:95], v[60:63], v[20:23], v[144:147]
    ds_read_b128 v[64:67], v5 offset:3840
    ds_read_b128 v[68:71], v153 offset:3840
    s_nop 3
    v_rcp_f32 v86, v86
    s_nop 0
    v_mul_f32 v80, v80, v86
    v_mul_f32 v81, v81, v86
    v_mul_f32 v82, v82, v86
    v_mul_f32 v83, v83, v86
    v_mul_f32 v84, v84, v86
    v_mul_f32 v85, v85, v86
    v_cvt_pk_bf16_f32 v96, v80, v81
    v_cvt_pk_bf16_f32 v97, v82, v83
    v_cvt_pk_bf16_f32 v84, v84, v85
    v_or_b32 v100, v100, v84
    ds_read_b128 v[72:75], v5 offset:4800
    ds_read_b128 v[76:79], v154 offset:4800
    s_nop 1
    v_rcp_f32 v94, v94
    s_nop 0
    v_mul_f32 v88, v88, v94
    v_mul_f32 v89, v89, v94
    v_mul_f32 v90, v90, v94
    v_mul_f32 v91, v91, v94
    v_mul_f32 v92, v92, v94
    v_mul_f32 v93, v93, v94
    v_cvt_pk_bf16_f32 v98, v88, v89
    v_cvt_pk_bf16_f32 v99, v90, v91
    v_cvt_pk_bf16_f32 v92, v92, v93
    v_or_b32 v100, v100, v92
    s_waitcnt lgkmcnt(4)
    s_nop 0
    v_mfma_f32_16x16x32_bf16 v[124:127], v[104:107], v[96:99], v[124:127]
    v_mfma_f32_16x16x32_bf16 v[128:131], v[108:111], v[96:99], v[128:131]
    v_mfma_f32_16x16x32_bf16 v[132:135], v[112:115], v[96:99], v[132:135]
    v_mfma_f32_16x16x32_bf16 v[136:139], v[116:119], v[96:99], v[136:139]
    v_mfma_f32_16x16x32_bf16 v[140:143], v[120:123], v[96:99], v[140:143]
    ds_read_b64_tr_b16 v[104:105], v6 offset:10240
    ds_read_b64_tr_b16 v[106:107], v6 offset:11520
    ds_read_b64_tr_b16 v[108:109], v6 offset:10272
    ds_read_b64_tr_b16 v[110:111], v6 offset:11552
    ds_read_b64_tr_b16 v[112:113], v6 offset:10304
    ds_read_b64_tr_b16 v[114:115], v6 offset:11584
    ds_read_b64_tr_b16 v[116:117], v6 offset:10336
    ds_read_b64_tr_b16 v[118:119], v6 offset:11616
    ds_read_b64_tr_b16 v[120:121], v6 offset:10368
    ds_read_b64_tr_b16 v[122:123], v6 offset:11648
    s_waitcnt lgkmcnt(12)
    s_waitcnt vmcnt(8)
    v_mfma_f32_16x16x32_bf16 v[80:83], v[64:67], v[24:27], 0
    v_mfma_f32_16x16x32_bf16 v[84:87], v[68:71], v[24:27], v[144:147]
    s_waitcnt lgkmcnt(10)
    s_waitcnt vmcnt(7)
    v_mfma_f32_16x16x32_bf16 v[88:91], v[72:75], v[28:31], 0
    v_mfma_f32_16x16x32_bf16 v[92:95], v[76:79], v[28:31], v[144:147]
    ds_read_b128 v[56:59], v5 offset:5760
    ds_read_b128 v[60:63], v155 offset:5760
    s_nop 3
    v_rcp_f32 v86, v86
    s_nop 0
    v_mul_f32 v80, v80, v86
    v_mul_f32 v81, v81, v86
    v_mul_f32 v82, v82, v86
    v_mul_f32 v83, v83, v86
    v_mul_f32 v84, v84, v86
    v_mul_f32 v85, v85, v86
    v_cvt_pk_bf16_f32 v96, v80, v81
    v_cvt_pk_bf16_f32 v97, v82, v83
    v_cvt_pk_bf16_f32 v84, v84, v85
    v_or_b32 v101, v101, v84
    ds_read_b128 v[64:67], v5 offset:6720
    ds_read_b128 v[68:71], v156 offset:6720
    s_nop 1
    v_rcp_f32 v94, v94
    s_nop 0
    v_mul_f32 v88, v88, v94
    v_mul_f32 v89, v89, v94
    v_mul_f32 v90, v90, v94
    v_mul_f32 v91, v91, v94
    v_mul_f32 v92, v92, v94
    v_mul_f32 v93, v93, v94
    v_cvt_pk_bf16_f32 v98, v88, v89
    v_cvt_pk_bf16_f32 v99, v90, v91
    v_cvt_pk_bf16_f32 v92, v92, v93
    v_or_b32 v101, v101, v92
    s_waitcnt lgkmcnt(4)
    s_nop 0
    v_mfma_f32_16x16x32_bf16 v[124:127], v[104:107], v[96:99], v[124:127]
    v_mfma_f32_16x16x32_bf16 v[128:131], v[108:111], v[96:99], v[128:131]
    v_mfma_f32_16x16x32_bf16 v[132:135], v[112:115], v[96:99], v[132:135]
    v_mfma_f32_16x16x32_bf16 v[136:139], v[116:119], v[96:99], v[136:139]
    v_mfma_f32_16x16x32_bf16 v[140:143], v[120:123], v[96:99], v[140:143]
    ds_read_b64_tr_b16 v[104:105], v6 offset:15360
    ds_read_b64_tr_b16 v[106:107], v6 offset:16640
    ds_read_b64_tr_b16 v[108:109], v6 offset:15392
    ds_read_b64_tr_b16 v[110:111], v6 offset:16672
    ds_read_b64_tr_b16 v[112:113], v6 offset:15424
    ds_read_b64_tr_b16 v[114:115], v6 offset:16704
    ds_read_b64_tr_b16 v[116:117], v6 offset:15456
    ds_read_b64_tr_b16 v[118:119], v6 offset:16736
    ds_read_b64_tr_b16 v[120:121], v6 offset:15488
    ds_read_b64_tr_b16 v[122:123], v6 offset:16768
    s_waitcnt lgkmcnt(12)
    s_waitcnt vmcnt(6)
    v_mfma_f32_16x16x32_bf16 v[80:83], v[56:59], v[32:35], 0
    v_mfma_f32_16x16x32_bf16 v[84:87], v[60:63], v[32:35], v[144:147]
    s_waitcnt lgkmcnt(10)
    s_waitcnt vmcnt(5)
    v_mfma_f32_16x16x32_bf16 v[88:91], v[64:67], v[36:39], 0
    v_mfma_f32_16x16x32_bf16 v[92:95], v[68:71], v[36:39], v[144:147]
    ds_read_b128 v[72:75], v5 offset:7680
    ds_read_b128 v[76:79], v153 offset:7680
    s_nop 3
    v_rcp_f32 v86, v86
    s_nop 0
    v_mul_f32 v80, v80, v86
    v_mul_f32 v81, v81, v86
    v_mul_f32 v82, v82, v86
    v_mul_f32 v83, v83, v86
    v_mul_f32 v84, v84, v86
    v_mul_f32 v85, v85, v86
    v_cvt_pk_bf16_f32 v96, v80, v81
    v_cvt_pk_bf16_f32 v97, v82, v83
    v_cvt_pk_bf16_f32 v84, v84, v85
    v_or_b32 v101, v101, v84
    ds_read_b128 v[56:59], v5 offset:8640
    ds_read_b128 v[60:63], v154 offset:8640
    s_nop 1
    v_rcp_f32 v94, v94
    s_nop 0
    v_mul_f32 v88, v88, v94
    v_mul_f32 v89, v89, v94
    v_mul_f32 v90, v90, v94
    v_mul_f32 v91, v91, v94
    v_mul_f32 v92, v92, v94
    v_mul_f32 v93, v93, v94
    v_cvt_pk_bf16_f32 v98, v88, v89
    v_cvt_pk_bf16_f32 v99, v90, v91
    v_cvt_pk_bf16_f32 v92, v92, v93
    v_or_b32 v101, v101, v92
    s_waitcnt lgkmcnt(4)
    s_nop 0
    v_mfma_f32_16x16x32_bf16 v[124:127], v[104:107], v[96:99], v[124:127]
    v_mfma_f32_16x16x32_bf16 v[128:131], v[108:111], v[96:99], v[128:131]
    v_mfma_f32_16x16x32_bf16 v[132:135], v[112:115], v[96:99], v[132:135]
    v_mfma_f32_16x16x32_bf16 v[136:139], v[116:119], v[96:99], v[136:139]
    v_mfma_f32_16x16x32_bf16 v[140:143], v[120:123], v[96:99], v[140:143]
    ds_read_b64_tr_b16 v[104:105], v6 offset:20480
    ds_read_b64_tr_b16 v[106:107], v6 offset:21760
    ds_read_b64_tr_b16 v[108:109], v6 offset:20512
    ds_read_b64_tr_b16 v[110:111], v6 offset:21792
    ds_read_b64_tr_b16 v[112:113], v6 offset:20544
    ds_read_b64_tr_b16 v[114:115], v6 offset:21824
    ds_read_b64_tr_b16 v[116:117], v6 offset:20576
    ds_read_b64_tr_b16 v[118:119], v6 offset:21856
    ds_read_b64_tr_b16 v[120:121], v6 offset:20608
    ds_read_b64_tr_b16 v[122:123], v6 offset:21888
    s_waitcnt lgkmcnt(12)
    s_waitcnt vmcnt(4)
    v_mfma_f32_16x16x32_bf16 v[80:83], v[72:75], v[40:43], 0
    v_mfma_f32_16x16x32_bf16 v[84:87], v[76:79], v[40:43], v[144:147]
    s_waitcnt lgkmcnt(10)
    s_waitcnt vmcnt(3)
    v_mfma_f32_16x16x32_bf16 v[88:91], v[56:59], v[44:47], 0
    v_mfma_f32_16x16x32_bf16 v[92:95], v[60:63], v[44:47], v[144:147]
    s_nop 3
    v_rcp_f32 v86, v86
    s_nop 0
    v_mul_f32 v80, v80, v86
    v_mul_f32 v81, v81, v86
    v_mul_f32 v82, v82, v86
    v_mul_f32 v83, v83, v86
    v_mul_f32 v84, v84, v86
    v_mul_f32 v85, v85, v86
    v_cvt_pk_bf16_f32 v96, v80, v81
    v_cvt_pk_bf16_f32 v97, v82, v83
    v_cvt_pk_bf16_f32 v84, v84, v85
    v_or_b32 v102, v102, v84
    s_nop 1
    v_rcp_f32 v94, v94
    s_nop 0
    v_mul_f32 v88, v88, v94
    v_mul_f32 v89, v89, v94
    v_mul_f32 v90, v90, v94
    v_mul_f32 v91, v91, v94
    v_mul_f32 v92, v92, v94
    v_mul_f32 v93, v93, v94
    v_cvt_pk_bf16_f32 v98, v88, v89
    v_cvt_pk_bf16_f32 v99, v90, v91
    v_cvt_pk_bf16_f32 v92, v92, v93
    v_or_b32 v102, v102, v92
    s_waitcnt lgkmcnt(0)
    s_nop 0
    v_mfma_f32_16x16x32_bf16 v[124:127], v[104:107], v[96:99], v[124:127]
    v_mfma_f32_16x16x32_bf16 v[128:131], v[108:111], v[96:99], v[128:131]
    v_mfma_f32_16x16x32_bf16 v[132:135], v[112:115], v[96:99], v[132:135]
    v_mfma_f32_16x16x32_bf16 v[136:139], v[116:119], v[96:99], v[136:139]
    v_mfma_f32_16x16x32_bf16 v[140:143], v[120:123], v[96:99], v[140:143]
    ds_read_b64_tr_b16 v[104:105], v6 offset:25600
    ds_read_b64_tr_b16 v[106:107], v6 offset:26880
    ds_read_b64_tr_b16 v[108:109], v6 offset:25632
    ds_read_b64_tr_b16 v[110:111], v6 offset:26912
    ds_read_b64_tr_b16 v[112:113], v6 offset:25664
    ds_read_b64_tr_b16 v[114:115], v6 offset:26944
    ds_read_b64_tr_b16 v[116:117], v6 offset:25696
    ds_read_b64_tr_b16 v[118:119], v6 offset:26976
    ds_read_b64_tr_b16 v[120:121], v6 offset:25728
    ds_read_b64_tr_b16 v[122:123], v6 offset:27008
    s_waitcnt lgkmcnt(0)
    v_mfma_f32_16x16x32_bf16 v[124:127], v[104:107], v[100:103], v[124:127]
    v_mfma_f32_16x16x32_bf16 v[128:131], v[108:111], v[100:103], v[128:131]
    v_mfma_f32_16x16x32_bf16 v[132:135], v[112:115], v[100:103], v[132:135]
    v_mfma_f32_16x16x32_bf16 v[136:139], v[116:119], v[100:103], v[136:139]
    v_mfma_f32_16x16x32_bf16 v[140:143], v[120:123], v[100:103], v[140:143]
mega_B15_rj:
    s_waitcnt vmcnt(0) lgkmcnt(0)
    s_barrier
    s_add_u32 s12, s4, 0x29a0000
    s_addc_u32 s13, s5, 0
    s_mov_b32 s14, 0xb4000
    s_mov_b32 s15, 0x20000
    s_mul_i32 s40, s21, 92160
    s_lshl_b32 s41, s22, 10
    s_add_u32 s42, s41, 0
    s_mov_b32 m0, s42
    s_add_u32 s43, s40, s42
    buffer_load_dwordx4 v2, s[12:15], s43 offen lds
    s_add_u32 s42, s41, 12288
    s_mov_b32 m0, s42
    s_add_u32 s43, s40, s42
    buffer_load_dwordx4 v2, s[12:15], s43 offen lds
    s_add_u32 s42, s41, 24576
    s_mov_b32 m0, s42
    s_add_u32 s43, s40, s42
    buffer_load_dwordx4 v2, s[12:15], s43 offen lds
    s_add_u32 s42, s41, 36864
    s_mov_b32 m0, s42
    s_add_u32 s43, s40, s42
    buffer_load_dwordx4 v2, s[12:15], s43 offen lds
    s_add_u32 s42, s41, 49152
    s_mov_b32 m0, s42
    s_add_u32 s43, s40, s42
    buffer_load_dwordx4 v2, s[12:15], s43 offen lds
    s_add_u32 s42, s41, 61440
    s_mov_b32 m0, s42
    s_add_u32 s43, s40, s42
    buffer_load_dwordx4 v2, s[12:15], s43 offen lds
    s_add_u32 s42, s41, 73728
    s_mov_b32 m0, s42
    s_add_u32 s43, s40, s42
    buffer_load_dwordx4 v2, s[12:15], s43 offen lds
    s_add_u32 s42, s41, 86016
    s_cmp_ge_u32 s42, 92160
    s_cselect_b32 s43, 12288, 0
    s_sub_u32 s42, s42, s43
    s_mov_b32 m0, s42
    s_add_u32 s43, s40, s42
    buffer_load_dwordx4 v2, s[12:15], s43 offen lds
    s_mul_i32 s40, s22, 5120
    s_add_u32 s40, s40, 97280
    v_add_u32 v5, s40, v2
    s_nop 7
    ds_write_b128 v5, v[124:127] offset:0
    ds_write_b128 v5, v[128:131] offset:1024
    ds_write_b128 v5, v[132:135] offset:2048
    ds_write_b128 v5, v[136:139] offset:3072
    ds_write_b128 v5, v[140:143] offset:4096
    s_waitcnt lgkmcnt(0)
    s_barrier
    s_mul_i32 s32, s24, 5120
    s_lshl_b32 s33, s25, 11
    s_add_u32 s33, s32, s33
    s_add_u32 s33, s33, 97280
    v_add_u32 v5, s33, v2
    s_mul_i32 s32, s24, 5120
    s_add_u32 s32, s32, 101888
    v_lshlrev_b32 v110, 4, v3
    v_add_u32 v110, s32, v110
    ds_read_b64 v[124:125], v110 offset:0
    ds_read_b64 v[126:127], v110 offset:20480
    ds_read_b64 v[128:129], v110 offset:40960
    ds_read_b128 v[104:107], v5 offset:0
    ds_read_b128 v[108:111], v5 offset:20480
    ds_read_b128 v[112:115], v5 offset:40960
    ds_read_b128 v[56:59], v5 offset:1024
    ds_read_b128 v[60:63], v5 offset:21504
    ds_read_b128 v[64:67], v5 offset:41984
    s_nop 1
    v_permlane16_swap_b32 v148, v150
    v_permlane16_swap_b32 v149, v151
    s_nop 1
    v_lshlrev_b32 v72, 16, v148
    v_and_b32 v73, 0xffff0000, v148
    v_lshlrev_b32 v74, 16, v149
    v_and_b32 v75, 0xffff0000, v149
    v_lshlrev_b32 v76, 16, v150
    v_and_b32 v77, 0xffff0000, v150
    v_lshlrev_b32 v78, 16, v151
    v_and_b32 v79, 0xffff0000, v151
    s_waitcnt lgkmcnt(6)
    v_add_f32 v124, v124, v125
    v_add_f32 v126, v126, v127
    v_add_f32 v128, v128, v129
    v_add_f32 v124, v124, v126
    v_add_f32 v124, v124, v128
    v_add_f32 v124, v124, v152
    s_waitcnt lgkmcnt(0)
    v_add_f32 v104, v104, v108
    v_add_f32 v105, v105, v109
    v_add_f32 v106, v106, v110
    v_add_f32 v107, v107, v111
    v_add_f32 v104, v104, v112
    v_add_f32 v105, v105, v113
    v_add_f32 v106, v106, v114
    v_add_f32 v107, v107, v115
    v_add_f32 v56, v56, v60
    v_add_f32 v57, v57, v61
    v_add_f32 v58, v58, v62
    v_add_f32 v59, v59, v63
    v_add_f32 v56, v56, v64
    v_add_f32 v57, v57, v65
    v_add_f32 v58, v58, v66
    v_add_f32 v59, v59, v67
    v_mov_b32 v130, 0
    v_add_f32 v104, v104, v72
    v_add_f32 v105, v105, v73
    v_add_f32 v106, v106, v74
    v_add_f32 v107, v107, v75
    v_sub_f32 v104, v104, v124
    v_sub_f32 v105, v105, v124
    v_sub_f32 v106, v106, v124
    v_sub_f32 v107, v107, v124
    v_add_f32 v56, v56, v76
    v_add_f32 v57, v57, v77
    v_add_f32 v58, v58, v78
    v_add_f32 v59, v59, v79
    v_sub_f32 v56, v56, v124
    v_sub_f32 v57, v57, v124
    v_sub_f32 v58, v58, v124
    v_sub_f32 v59, v59, v124
    s_cmp_eq_u32 s25, 2
    s_cbranch_scc1 mega_B15_q2
    v_fmac_f32 v130, v104, v104
    v_fmac_f32 v130, v105, v105
    v_fmac_f32 v130, v106, v106
    v_fmac_f32 v130, v107, v107
    v_fmac_f32 v130, v56, v56
    v_fmac_f32 v130, v57, v57
    v_fmac_f32 v130, v58, v58
    v_fmac_f32 v130, v59, v59
    s_branch mega_B15_q3
mega_B15_q2:
    s_mov_b32 exec_lo, 0xffffffff
    s_mov_b32 exec_hi, 0x0
    v_fmac_f32 v130, v104, v104
    v_fmac_f32 v130, v105, v105
    v_fmac_f32 v130, v106, v106
    v_fmac_f32 v130, v107, v107
    s_mov_b64 exec, -1
mega_B15_q3:
    v_cvt_pk_bf16_f32 v80, v104, v105
    v_cvt_pk_bf16_f32 v81, v106, v107
    v_cvt_pk_bf16_f32 v82, v56, v57
    v_cvt_pk_bf16_f32 v83, v58, v59
    s_nop 1
    v_permlane16_swap_b32 v80, v82
    v_permlane16_swap_b32 v81, v83
    s_nop 1
    s_mul_i32 s36, s26, 72
    s_mul_i32 s33, s21, 9
    s_add_u32 s36, s36, s33
    s_lshl_b32 s33, s25, 2
    s_add_u32 s36, s36, s33
    s_lshl_b32 s36, s36, 8
    s_cmp_eq_u32 s25, 2
    s_cbranch_scc0 mega_B15_om
    s_mov_b32 exec_lo, 0xffff
    s_mov_b32 exec_hi, 0x0
mega_B15_om:
    buffer_store_dwordx4 v[80:83], v7, s[44:47], s36 offen sc1
    s_mov_b64 exec, -1
    v_mov_b32 v110, v130
    s_nop 1
    v_permlane16_swap_b32 v110, v130
    s_nop 1
    v_add_f32 v130, v130, v110
    v_mov_b32 v110, v130
    s_nop 1
    v_permlane32_swap_b32 v110, v130
    s_nop 1
    v_add_f32 v130, v130, v110
    s_mul_i32 s33, s21, 3
    s_add_u32 s33, s33, s25
    s_lshl_b32 s33, s33, 2
    v_add_u32 v110, s30, v3
    v_lshlrev_b32 v110, 7, v110
    v_add_u32 v110, s33, v110
    s_mov_b32 exec_lo, 0xffff
    s_mov_b32 exec_hi, 0x0
    buffer_store_dword v130, v110, s[52:55], 0 offen sc1
    s_mov_b64 exec, -1
    s_or_b32 s33, s21, s25
    s_cmp_lg_u32 s33, 0
    s_cbranch_scc1 mega_B15_nm
    v_add_u32 v110, s30, v3
    v_lshlrev_b32 v110, 2, v110
    s_mov_b32 exec_lo, 0xffff
    s_mov_b32 exec_hi, 0x0
    buffer_store_dword v124, v110, s[48:51], 0 offen sc1
    s_mov_b64 exec, -1
mega_B15_nm:
    s_waitcnt vmcnt(0)
    s_barrier
    s_cmp_lg_u32 s22, 0
    s_cbranch_scc1 mega_sg20
    s_add_u32 s82, s20, 0
    s_lshl_b32 s82, s82, 7
    v_mov_b32 v110, s82
    v_mov_b32 v111, 1
    s_mov_b64 exec, 1
    buffer_atomic_add v111, v110, s[84:87], 0 offen sc1
    s_cmp_ge_u32 s2, 192
    s_cbranch_scc1 mega_sg20
    s_and_b32 s82, s2, 7
    s_add_u32 s82, s82, 144
    s_lshl_b32 s82, s82, 7
    v_mov_b32 v110, s82
    buffer_atomic_add v111, v110, s[84:87], 0 offen sc1
mega_sg20:
    s_mov_b64 exec, -1
    v_and_b32 v1, 63, v0
    v_lshlrev_b32 v2, 4, v1
    v_and_b32 v3, 15, v1
    v_lshrrev_b32 v4, 4, v1
    s_and_b32 s20, s2, 7
    s_lshr_b32 s21, s2, 3
    s_lshl_b32 s20, s20, 2
    s_and_b32 s23, s21, 3
    s_add_u32 s20, s20, s23
    s_lshr_b32 s21, s21, 2
    s_and_b32 s24, s22, 3
    s_lshr_b32 s25, s22, 2
    s_lshl_b32 s26, s20, 2
    s_add_u32 s26, s26, s24
    s_lshl_b32 s30, s26, 4
    s_add_u32 s33, s20, 0
    s_waitcnt vmcnt(0)
    s_cmp_lg_u32 s22, 0
    s_cbranch_scc1 mega_wc22
    v_and_b32 v1, 63, v0
    v_add_u32 v2, s33, v1
    v_lshlrev_b32 v1, 7, v2
    s_mov_b32 exec_lo, 0x1
    s_mov_b32 exec_hi, 0x0
    s_mov_b32 s82, 0
mega_pl23:
    buffer_load_dword v2, v1, s[84:87], 0 offen sc1
    s_waitcnt vmcnt(0)
    v_cmp_gt_u32 vcc, 8, v2
    s_add_u32 s82, s82, 1
    s_cmp_gt_u32 s82, 400000
    s_cbranch_scc1 mega_pl23_x
    s_cbranch_vccz mega_pl23_x
    s_sleep 1
    s_branch mega_pl23
mega_pl23_x:
    s_mov_b64 exec, -1
mega_wc22:
    s_barrier
    v_and_b32 v1, 63, v0
    v_lshlrev_b32 v2, 4, v1
    v_and_b32 v3, 15, v1
    v_lshrrev_b32 v4, 4, v1
    s_mul_i32 s27, s26, 18
    s_mul_i32 s28, s25, 6
    s_add_u32 s27, s27, s28
    s_lshl_b32 s27, s27, 10
    s_add_u32 s8, s4, 0x20e0000
    s_addc_u32 s9, s5, 0
    s_mov_b32 s10, 0x240000
    s_mov_b32 s11, 0x20000
    buffer_load_dwordx4 v[8:11], v2, s[8:11], s27 offen offset:0 sc1
    buffer_load_dwordx4 v[12:15], v2, s[8:11], s27 offen offset:1024 sc1
    buffer_load_dwordx4 v[16:19], v2, s[8:11], s27 offen offset:2048 sc1
    buffer_load_dwordx4 v[20:23], v2, s[8:11], s27 offen offset:3072 sc1
    s_add_u32 s27, s27, 4096
    buffer_load_dwordx4 v[24:27], v2, s[8:11], s27 offen offset:0 sc1
    buffer_load_dwordx4 v[28:31], v2, s[8:11], s27 offen offset:1024 sc1
    s_add_u32 s16, s4, 0x2320000
    s_addc_u32 s17, s5, 0
    s_mov_b32 s18, 0x40000
    s_mov_b32 s19, 0x20000
    v_add_u32 v5, s30, v3
    v_lshlrev_b32 v5, 7, v5
    v_lshl_add_u32 v5, v4, 5, v5
    v_cmp_eq_u32 vcc, 3, v4
    v_mov_b32 v6, 0x7fffff00
    s_nop 0
    v_cndmask_b32 v5, v5, v6, vcc
    buffer_load_dwordx4 v[92:95], v5, s[16:19], 0 offen sc1
    buffer_load_dwordx4 v[96:99], v5, s[16:19], 0 offen offset:16 sc1
    s_add_u32 s44, s4, 0x2370000
    s_addc_u32 s45, s5, 0
    s_mov_b32 s46, 0x240000
    s_mov_b32 s47, 0x20000
    v_lshrrev_b32 v5, 5, v1
    v_lshlrev_b32 v5, 4, v5
    v_bfe_u32 v6, v1, 4, 1
    v_lshl_add_u32 v5, v6, 2, v5
    v_bfe_u32 v6, v1, 2, 2
    v_add_u32 v5, v5, v6
    v_mul_u32_u24 v5, 160, v5
    v_and_b32 v6, 3, v1
    v_lshl_add_u32 v5, v6, 3, v5
    s_mul_i32 s31, s28, 5120
    v_add_u32 v5, s31, v5
    s_waitcnt vmcnt(2)
    ds_read_b64_tr_b16 v[32:33], v5 offset:0
    ds_read_b64_tr_b16 v[34:35], v5 offset:1280
    ds_read_b64_tr_b16 v[36:37], v5 offset:32
    ds_read_b64_tr_b16 v[38:39], v5 offset:1312
    ds_read_b64_tr_b16 v[40:41], v5 offset:64
    ds_read_b64_tr_b16 v[42:43], v5 offset:1344
    ds_read_b64_tr_b16 v[44:45], v5 offset:96
    ds_read_b64_tr_b16 v[46:47], v5 offset:1376
    ds_read_b64_tr_b16 v[48:49], v5 offset:128
    ds_read_b64_tr_b16 v[50:51], v5 offset:1408
    ds_read_b64_tr_b16 v[52:53], v5 offset:5120
    ds_read_b64_tr_b16 v[54:55], v5 offset:6400
    ds_read_b64_tr_b16 v[56:57], v5 offset:5152
    ds_read_b64_tr_b16 v[58:59], v5 offset:6432
    ds_read_b64_tr_b16 v[60:61], v5 offset:5184
    ds_read_b64_tr_b16 v[62:63], v5 offset:6464
    ds_read_b64_tr_b16 v[64:65], v5 offset:5216
    ds_read_b64_tr_b16 v[66:67], v5 offset:6496
    ds_read_b64_tr_b16 v[68:69], v5 offset:5248
    ds_read_b64_tr_b16 v[70:71], v5 offset:6528
    s_waitcnt lgkmcnt(10)
    v_mfma_f32_16x16x32_bf16 v[72:75], v[32:35], v[8:11], 0
    v_mfma_f32_16x16x32_bf16 v[76:79], v[36:39], v[8:11], 0
    v_mfma_f32_16x16x32_bf16 v[80:83], v[40:43], v[8:11], 0
    v_mfma_f32_16x16x32_bf16 v[84:87], v[44:47], v[8:11], 0
    v_mfma_f32_16x16x32_bf16 v[88:91], v[48:51], v[8:11], 0
    ds_read_b64_tr_b16 v[32:33], v5 offset:10240
    ds_read_b64_tr_b16 v[34:35], v5 offset:11520
    ds_read_b64_tr_b16 v[36:37], v5 offset:10272
    ds_read_b64_tr_b16 v[38:39], v5 offset:11552
    ds_read_b64_tr_b16 v[40:41], v5 offset:10304
    ds_read_b64_tr_b16 v[42:43], v5 offset:11584
    ds_read_b64_tr_b16 v[44:45], v5 offset:10336
    ds_read_b64_tr_b16 v[46:47], v5 offset:11616
    ds_read_b64_tr_b16 v[48:49], v5 offset:10368
    ds_read_b64_tr_b16 v[50:51], v5 offset:11648
    s_waitcnt lgkmcnt(10)
    v_mfma_f32_16x16x32_bf16 v[72:75], v[52:55], v[12:15], v[72:75]
    v_mfma_f32_16x16x32_bf16 v[76:79], v[56:59], v[12:15], v[76:79]
    v_mfma_f32_16x16x32_bf16 v[80:83], v[60:63], v[12:15], v[80:83]
    v_mfma_f32_16x16x32_bf16 v[84:87], v[64:67], v[12:15], v[84:87]
    v_mfma_f32_16x16x32_bf16 v[88:91], v[68:71], v[12:15], v[88:91]
    ds_read_b64_tr_b16 v[52:53], v5 offset:15360
    ds_read_b64_tr_b16 v[54:55], v5 offset:16640
    ds_read_b64_tr_b16 v[56:57], v5 offset:15392
    ds_read_b64_tr_b16 v[58:59], v5 offset:16672
    ds_read_b64_tr_b16 v[60:61], v5 offset:15424
    ds_read_b64_tr_b16 v[62:63], v5 offset:16704
    ds_read_b64_tr_b16 v[64:65], v5 offset:15456
    ds_read_b64_tr_b16 v[66:67], v5 offset:16736
    ds_read_b64_tr_b16 v[68:69], v5 offset:15488
    ds_read_b64_tr_b16 v[70:71], v5 offset:16768
    s_waitcnt lgkmcnt(10)
    v_mfma_f32_16x16x32_bf16 v[72:75], v[32:35], v[16:19], v[72:75]
    v_mfma_f32_16x16x32_bf16 v[76:79], v[36:39], v[16:19], v[76:79]
    v_mfma_f32_16x16x32_bf16 v[80:83], v[40:43], v[16:19], v[80:83]
    v_mfma_f32_16x16x32_bf16 v[84:87], v[44:47], v[16:19], v[84:87]
    v_mfma_f32_16x16x32_bf16 v[88:91], v[48:51], v[16:19], v[88:91]
    ds_read_b64_tr_b16 v[32:33], v5 offset:20480
    ds_read_b64_tr_b16 v[34:35], v5 offset:21760
    ds_read_b64_tr_b16 v[36:37], v5 offset:20512
    ds_read_b64_tr_b16 v[38:39], v5 offset:21792
    ds_read_b64_tr_b16 v[40:41], v5 offset:20544
    ds_read_b64_tr_b16 v[42:43], v5 offset:21824
    ds_read_b64_tr_b16 v[44:45], v5 offset:20576
    ds_read_b64_tr_b16 v[46:47], v5 offset:21856
    ds_read_b64_tr_b16 v[48:49], v5 offset:20608
    ds_read_b64_tr_b16 v[50:51], v5 offset:21888
    s_waitcnt lgkmcnt(10)
    v_mfma_f32_16x16x32_bf16 v[72:75], v[52:55], v[20:23], v[72:75]
    v_mfma_f32_16x16x32_bf16 v[76:79], v[56:59], v[20:23], v[76:79]
    v_mfma_f32_16x16x32_bf16 v[80:83], v[60:63], v[20:23], v[80:83]
    v_mfma_f32_16x16x32_bf16 v[84:87], v[64:67], v[20:23], v[84:87]
    v_mfma_f32_16x16x32_bf16 v[88:91], v[68:71], v[20:23], v[88:91]
    ds_read_b64_tr_b16 v[52:53], v5 offset:25600
    ds_read_b64_tr_b16 v[54:55], v5 offset:26880
    ds_read_b64_tr_b16 v[56:57], v5 offset:25632
    ds_read_b64_tr_b16 v[58:59], v5 offset:26912
    ds_read_b64_tr_b16 v[60:61], v5 offset:25664
    ds_read_b64_tr_b16 v[62:63], v5 offset:26944
    ds_read_b64_tr_b16 v[64:65], v5 offset:25696
    ds_read_b64_tr_b16 v[66:67], v5 offset:26976
    ds_read_b64_tr_b16 v[68:69], v5 offset:25728
    ds_read_b64_tr_b16 v[70:71], v5 offset:27008
    s_waitcnt lgkmcnt(10)
    v_mfma_f32_16x16x32_bf16 v[72:75], v[32:35], v[24:27], v[72:75]
    v_mfma_f32_16x16x32_bf16 v[76:79], v[36:39], v[24:27], v[76:79]
    v_mfma_f32_16x16x32_bf16 v[80:83], v[40:43], v[24:27], v[80:83]
    v_mfma_f32_16x16x32_bf16 v[84:87], v[44:47], v[24:27], v[84:87]
    v_mfma_f32_16x16x32_bf16 v[88:91], v[48:51], v[24:27], v[88:91]
    s_waitcnt lgkmcnt(0)
    v_mfma_f32_16x16x32_bf16 v[72:75], v[52:55], v[28:31], v[72:75]
    v_mfma_f32_16x16x32_bf16 v[76:79], v[56:59], v[28:31], v[76:79]
    v_mfma_f32_16x16x32_bf16 v[80:83], v[60:63], v[28:31], v[80:83]
    v_mfma_f32_16x16x32_bf16 v[84:87], v[64:67], v[28:31], v[84:87]
    v_mfma_f32_16x16x32_bf16 v[88:91], v[68:71], v[28:31], v[88:91]
    s_waitcnt vmcnt(0)
    v_add_f32 v92, v92, v93
    v_add_f32 v92, v92, v94
    v_add_f32 v92, v92, v95
    v_add_f32 v92, v92, v96
    v_add_f32 v92, v92, v97
    v_add_f32 v92, v92, v98
    v_add_f32 v92, v92, v99
    v_mov_b32 v6, v92
    s_nop 1
    v_permlane16_swap_b32 v6, v92
    s_nop 1
    v_add_f32 v92, v92, v6
    v_mov_b32 v6, v92
    s_nop 1
    v_permlane32_swap_b32 v6, v92
    s_nop 1
    v_add_f32 v92, v92, v6
    v_mov_b32 v93, 0x3727c5ac
    v_fmac_f32 v93, 0x3ae38e39, v92
    v_rsq_f32 v94, v93
    v_mul_f32 v95, 0x3ae38e39, v92
    v_mul_f32 v95, v95, v94
    v_mul_f32 v95, v95, v94
    v_add_f32 v95, 0x3727c5ac, v95
    v_mul_f32 v96, v93, v95
    v_rsq_f32 v97, v96
    s_nop 0
    v_mul_f32 v102, v96, v97
    v_mul_f32 v100, 0xc0135761, v97
    v_mul_f32 v98, v97, v97
    v_mul_f32 v98, v98, v97
    v_mul_f32 v101, 0xbdd2d3e8, v98
    s_mul_i32 s40, s22, 5120
    s_add_u32 s40, s40, 97280
    v_add_u32 v5, s40, v2
    s_nop 7
    ds_write_b128 v5, v[72:75] offset:0
    ds_write_b128 v5, v[76:79] offset:1024
    ds_write_b128 v5, v[80:83] offset:2048
    ds_write_b128 v5, v[84:87] offset:3072
    ds_write_b128 v5, v[88:91] offset:4096
    s_waitcnt lgkmcnt(0)
    s_barrier
    s_add_u32 s12, s4, 0x2a60000
    s_addc_u32 s13, s5, 0
    s_mov_b32 s14, 0xb4000
    s_mov_b32 s15, 0x20000
    s_mul_i32 s40, s21, 92160
    s_lshl_b32 s41, s22, 10
    s_add_u32 s42, s41, 0
    s_mov_b32 m0, s42
    s_add_u32 s43, s40, s42
    buffer_load_dwordx4 v2, s[12:15], s43 offen lds
    s_add_u32 s42, s41, 12288
    s_mov_b32 m0, s42
    s_add_u32 s43, s40, s42
    buffer_load_dwordx4 v2, s[12:15], s43 offen lds
    s_add_u32 s42, s41, 24576
    s_mov_b32 m0, s42
    s_add_u32 s43, s40, s42
    buffer_load_dwordx4 v2, s[12:15], s43 offen lds
    s_add_u32 s42, s41, 36864
    s_mov_b32 m0, s42
    s_add_u32 s43, s40, s42
    buffer_load_dwordx4 v2, s[12:15], s43 offen lds
    s_add_u32 s42, s41, 49152
    s_mov_b32 m0, s42
    s_add_u32 s43, s40, s42
    buffer_load_dwordx4 v2, s[12:15], s43 offen lds
    s_add_u32 s42, s41, 61440
    s_mov_b32 m0, s42
    s_add_u32 s43, s40, s42
    buffer_load_dwordx4 v2, s[12:15], s43 offen lds
    s_add_u32 s42, s41, 73728
    s_mov_b32 m0, s42
    s_add_u32 s43, s40, s42
    buffer_load_dwordx4 v2, s[12:15], s43 offen lds
    s_add_u32 s42, s41, 86016
    s_cmp_ge_u32 s42, 92160
    s_cselect_b32 s43, 12288, 0
    s_sub_u32 s42, s42, s43
    s_mov_b32 m0, s42
    s_add_u32 s43, s40, s42
    buffer_load_dwordx4 v2, s[12:15], s43 offen lds
    s_mul_i32 s32, s24, 5120
    s_lshl_b32 s33, s25, 11
    s_add_u32 s33, s32, s33
    s_add_u32 s33, s33, 97280
    v_add_u32 v5, s33, v2
    ds_read_b128 v[32:35], v5 offset:0
    ds_read_b128 v[36:39], v5 offset:20480
    ds_read_b128 v[40:43], v5 offset:40960
    ds_read_b128 v[44:47], v5 offset:1024
    ds_read_b128 v[48:51], v5 offset:21504
    ds_read_b128 v[52:55], v5 offset:41984
    v_and_b32 v6, 1, v4
    v_lshlrev_b32 v7, 9, v6
    v_lshrrev_b32 v6, 1, v4
    v_lshl_add_u32 v7, v6, 8, v7
    v_lshl_add_u32 v7, v3, 4, v7
    s_mul_i32 s36, s26, 72
    s_mul_i32 s33, s21, 9
    s_add_u32 s36, s36, s33
    s_lshl_b32 s33, s25, 2
    s_add_u32 s36, s36, s33
    s_lshl_b32 s36, s36, 8
    s_waitcnt lgkmcnt(3)
    v_add_f32 v32, v32, v36
    v_add_f32 v33, v33, v37
    v_add_f32 v34, v34, v38
    v_add_f32 v35, v35, v39
    v_add_f32 v32, v32, v40
    v_add_f32 v33, v33, v41
    v_add_f32 v34, v34, v42
    v_add_f32 v35, v35, v43
    v_mul_f32 v104, v32, v32
    v_mul_f32 v105, v33, v33
    v_mul_f32 v106, v34, v34
    v_mul_f32 v107, v35, v35
    v_fma_f32 v104, v104, v101, v100
    v_fma_f32 v105, v105, v101, v100
    v_fma_f32 v106, v106, v101, v100
    v_fma_f32 v107, v107, v101, v100
    v_mul_f32 v104, v104, v32
    v_mul_f32 v105, v105, v33
    v_mul_f32 v106, v106, v34
    v_mul_f32 v107, v107, v35
    v_exp_f32 v104, v104
    v_exp_f32 v105, v105
    v_exp_f32 v106, v106
    v_exp_f32 v107, v107
    v_fma_f32 v104, v104, v102, v102
    v_fma_f32 v105, v105, v102, v102
    v_fma_f32 v106, v106, v102, v102
    v_fma_f32 v107, v107, v102, v102
    v_rcp_f32 v104, v104
    v_rcp_f32 v105, v105
    v_rcp_f32 v106, v106
    v_rcp_f32 v107, v107
    v_mul_f32 v104, v104, v32
    v_mul_f32 v105, v105, v33
    v_mul_f32 v106, v106, v34
    v_mul_f32 v107, v107, v35
    v_cvt_pk_bf16_f32 v104, v104, v105
    v_cvt_pk_bf16_f32 v105, v106, v107
    s_waitcnt lgkmcnt(0)
    v_add_f32 v44, v44, v48
    v_add_f32 v45, v45, v49
    v_add_f32 v46, v46, v50
    v_add_f32 v47, v47, v51
    v_add_f32 v44, v44, v52
    v_add_f32 v45, v45, v53
    v_add_f32 v46, v46, v54
    v_add_f32 v47, v47, v55
    v_mul_f32 v108, v44, v44
    v_mul_f32 v109, v45, v45
    v_mul_f32 v110, v46, v46
    v_mul_f32 v111, v47, v47
    v_fma_f32 v108, v108, v101, v100
    v_fma_f32 v109, v109, v101, v100
    v_fma_f32 v110, v110, v101, v100
    v_fma_f32 v111, v111, v101, v100
    v_mul_f32 v108, v108, v44
    v_mul_f32 v109, v109, v45
    v_mul_f32 v110, v110, v46
    v_mul_f32 v111, v111, v47
    v_exp_f32 v108, v108
    v_exp_f32 v109, v109
    v_exp_f32 v110, v110
    v_exp_f32 v111, v111
    v_fma_f32 v108, v108, v102, v102
    v_fma_f32 v109, v109, v102, v102
    v_fma_f32 v110, v110, v102, v102
    v_fma_f32 v111, v111, v102, v102
    v_rcp_f32 v108, v108
    v_rcp_f32 v109, v109
    v_rcp_f32 v110, v110
    v_rcp_f32 v111, v111
    v_mul_f32 v108, v108, v44
    v_mul_f32 v109, v109, v45
    v_mul_f32 v110, v110, v46
    v_mul_f32 v111, v111, v47
    v_cvt_pk_bf16_f32 v108, v108, v109
    v_cvt_pk_bf16_f32 v109, v110, v111
    v_mov_b32 v106, v108
    v_mov_b32 v107, v109
    s_nop 1
    v_permlane16_swap_b32 v104, v106
    v_permlane16_swap_b32 v105, v107
    s_nop 1
    s_cmp_eq_u32 s25, 2
    s_cbranch_scc0 mega_C21_om
    s_mov_b32 exec_lo, 0xffff
    s_mov_b32 exec_hi, 0x0
mega_C21_om:
    buffer_store_dwordx4 v[104:107], v7, s[44:47], s36 offen sc1
    s_mov_b64 exec, -1
    s_waitcnt vmcnt(0)
    s_barrier
    s_cmp_lg_u32 s22, 0
    s_cbranch_scc1 mega_sg24
    s_add_u32 s82, s20, 32
    s_lshl_b32 s82, s82, 7
    v_mov_b32 v110, s82
    v_mov_b32 v111, 1
    s_mov_b64 exec, 1
    buffer_atomic_add v111, v110, s[84:87], 0 offen sc1
mega_sg24:
    s_mov_b64 exec, -1
    v_and_b32 v1, 63, v0
    v_lshlrev_b32 v2, 4, v1
    v_and_b32 v3, 15, v1
    v_lshrrev_b32 v4, 4, v1
    s_and_b32 s20, s2, 7
    s_lshr_b32 s21, s2, 3
    s_lshl_b32 s20, s20, 2
    s_and_b32 s23, s21, 3
    s_add_u32 s20, s20, s23
    s_lshr_b32 s21, s21, 2
    s_and_b32 s24, s22, 3
    s_lshr_b32 s25, s22, 2
    s_lshl_b32 s26, s20, 2
    s_add_u32 s26, s26, s24
    s_lshl_b32 s30, s26, 4
    s_add_u32 s16, s4, 0x2320000
    s_addc_u32 s17, s5, 0
    s_mov_b32 s18, 0x40000
    s_mov_b32 s19, 0x20000
    v_add_u32 v110, s30, v3
    v_lshlrev_b32 v110, 7, v110
    v_lshl_add_u32 v110, v4, 5, v110
    v_cmp_eq_u32 vcc, 3, v4
    v_mov_b32 v111, 0x7fffff00
    s_nop 0
    v_cndmask_b32 v110, v110, v111, vcc
    buffer_load_dwordx4 v[92:95], v110, s[16:19], 0 offen sc1
    buffer_load_dwordx4 v[96:99], v110, s[16:19], 0 offen offset:16 sc1
    v_and_b32 v110, 1, v4
    v_lshlrev_b32 v7, 9, v110
    v_lshrrev_b32 v110, 1, v4
    v_lshl_add_u32 v7, v110, 8, v7
    v_lshl_add_u32 v7, v3, 4, v7
    s_mul_i32 s36, s26, 72
    s_mul_i32 s33, s21, 9
    s_add_u32 s36, s36, s33
    s_lshl_b32 s33, s25, 2
    s_add_u32 s36, s36, s33
    s_lshl_b32 s36, s36, 8
    s_add_u32 s16, s4, 0x20e0000
    s_addc_u32 s17, s5, 0
    s_mov_b32 s18, 0x240000
    s_mov_b32 s19, 0x20000
    buffer_load_dwordx4 v[100:103], v7, s[16:19], s36 offen sc1
    s_add_u32 s16, s4, 0x2360000
    s_addc_u32 s17, s5, 0
    s_mov_b32 s18, 0x2000
    s_mov_b32 s19, 0x20000
    v_add_u32 v110, s30, v3
    v_lshlrev_b32 v110, 2, v110
    buffer_load_dword v104, v110, s[16:19], 0 offen sc1
    s_mov_b32 s31, -1
    s_mov_b32 s32, 1
    s_cmp_eq_u32 s25, 1
    s_cselect_b32 s31, 1, s31
    s_cselect_b32 s32, -2, s32
    s_cmp_eq_u32 s25, 2
    s_cselect_b32 s31, -2, s31
    s_cselect_b32 s32, 2, s32
    v_add_u32 v113, s30, v3
    v_add_u32 v113, s31, v113
    v_lshrrev_b32 v111, 4, v113
    v_mul_u32_u24 v111, 18432, v111
    v_and_b32 v114, 15, v113
    v_lshl_add_u32 v111, v114, 4, v111
    v_lshl_add_u32 v111, v4, 8, v111
    v_cmp_gt_u32 vcc, 2048, v113
    v_mov_b32 v114, 0x7fff0000
    s_nop 0
    v_cndmask_b32 v111, v114, v111, vcc
    v_add_u32 v113, s30, v3
    v_add_u32 v113, s32, v113
    v_lshrrev_b32 v112, 4, v113
    v_mul_u32_u24 v112, 18432, v112
    v_and_b32 v114, 15, v113
    v_lshl_add_u32 v112, v114, 4, v112
    v_lshl_add_u32 v112, v4, 8, v112
    v_cmp_gt_u32 vcc, 2048, v113
    v_mov_b32 v114, 0x7fff0000
    s_nop 0
    v_cndmask_b32 v112, v114, v112, vcc
    v_cmp_gt_u32 vcc, 2, v4
    s_nop 1
    v_cndmask_b32 v113, v112, v111, vcc
    s_add_u32 s33, s20, 31
    s_waitcnt vmcnt(0)
    s_and_b32 s34, s2, 3
    s_lshl_b32 s34, s34, 1
    s_lshr_b32 s35, s2, 7
    s_add_u32 s34, s34, s35
    s_add_u32 s34, s34, 144
    s_cmp_lg_u32 s22, 0
    s_cbranch_scc1 mega_wc26
    v_and_b32 v1, 63, v0
    v_add_u32 v2, s33, v1
    v_max_i32 v2, 32, v2
    v_min_i32 v2, 63, v2
    v_cmp_eq_u32 vcc, 3, v1
    v_mov_b32 v1, s34
    v_mov_b32 v163, 8
    v_cndmask_b32 v2, v2, v1, vcc
    v_cndmask_b32 v163, v163, 32, vcc
    v_lshlrev_b32 v1, 7, v2
    s_mov_b32 exec_lo, 0xf
    s_mov_b32 exec_hi, 0x0
    s_mov_b32 s82, 0
mega_pl27:
    buffer_load_dword v2, v1, s[84:87], 0 offen sc1
    s_waitcnt vmcnt(0)
    v_cmp_gt_u32 vcc, v163, v2
    s_add_u32 s82, s82, 1
    s_cmp_gt_u32 s82, 400000
    s_cbranch_scc1 mega_pl27_x
    s_cbranch_vccz mega_pl27_x
    s_sleep 1
    s_branch mega_pl27
mega_pl27_x:
    s_mov_b64 exec, -1
mega_wc26:
    s_barrier
    v_and_b32 v1, 63, v0
    v_lshlrev_b32 v2, 4, v1
    v_and_b32 v3, 15, v1
    v_lshrrev_b32 v4, 4, v1
    s_add_u32 s8, s4, 0x2370000
    s_addc_u32 s9, s5, 0
    s_mov_b32 s10, 0x240000
    s_mov_b32 s11, 0x20000
    s_mul_i32 s27, s25, 6144
    s_add_u32 s28, s27, 4096
    s_cmp_eq_u32 s25, 1
    s_cbranch_scc1 mega_D25_x1
    s_cmp_eq_u32 s25, 2
    s_cbranch_scc1 mega_D25_x2
    buffer_load_dwordx4 v[8:11], v111, s[8:11], s27 offen offset:0 sc1
    buffer_load_dwordx4 v[12:15], v111, s[8:11], s27 offen offset:1024 sc1
    buffer_load_dwordx4 v[16:19], v111, s[8:11], s27 offen offset:2048 sc1
    buffer_load_dwordx4 v[20:23], v111, s[8:11], s27 offen offset:3072 sc1
    buffer_load_dwordx4 v[24:27], v113, s[8:11], s28 offen offset:0 sc1
    buffer_load_dwordx4 v[28:31], v112, s[8:11], s28 offen offset:1024 sc1
    s_branch mega_D25_xd
mega_D25_x1:
    buffer_load_dwordx4 v[8:11], v111, s[8:11], s27 offen offset:0 sc1
    buffer_load_dwordx4 v[12:15], v111, s[8:11], s27 offen offset:1024 sc1
    buffer_load_dwordx4 v[16:19], v111, s[8:11], s27 offen offset:2048 sc1
    buffer_load_dwordx4 v[20:23], v112, s[8:11], s27 offen offset:3072 sc1
    buffer_load_dwordx4 v[24:27], v112, s[8:11], s28 offen offset:0 sc1
    buffer_load_dwordx4 v[28:31], v112, s[8:11], s28 offen offset:1024 sc1
    s_branch mega_D25_xd
mega_D25_x2:
    buffer_load_dwordx4 v[8:11], v111, s[8:11], s27 offen offset:0 sc1
    buffer_load_dwordx4 v[12:15], v113, s[8:11], s27 offen offset:1024 sc1
    buffer_load_dwordx4 v[16:19], v112, s[8:11], s27 offen offset:2048 sc1
    buffer_load_dwordx4 v[20:23], v112, s[8:11], s27 offen offset:3072 sc1
    buffer_load_dwordx4 v[24:27], v112, s[8:11], s28 offen offset:0 sc1
    buffer_load_dwordx4 v[28:31], v112, s[8:11], s28 offen offset:1024 sc1
mega_D25_xd:
    s_add_u32 s44, s4, 0xa20000
    s_addc_u32 s45, s5, 0
    s_mov_b32 s46, 0x240000
    s_mov_b32 s47, 0x20000
    s_add_u32 s48, s4, 0xc60000
    s_addc_u32 s49, s5, 0
    s_mov_b32 s50, 0x240000
    s_mov_b32 s51, 0x20000
    s_add_u32 s52, s4, 0xea0000
    s_addc_u32 s53, s5, 0
    s_mov_b32 s54, 0x40000
    s_mov_b32 s55, 0x20000
    s_mul_i32 s28, s25, 6
    v_lshrrev_b32 v5, 5, v1
    v_lshlrev_b32 v5, 4, v5
    v_bfe_u32 v110, v1, 4, 1
    v_lshl_add_u32 v5, v110, 2, v5
    v_bfe_u32 v110, v1, 2, 2
    v_add_u32 v5, v5, v110
    v_mul_u32_u24 v5, 160, v5
    v_and_b32 v110, 3, v1
    v_lshl_add_u32 v5, v110, 3, v5
    s_mul_i32 s31, s28, 5120
    v_add_u32 v5, s31, v5
    v_add_f32 v92, v92, v93
    v_add_f32 v92, v92, v94
    v_add_f32 v92, v92, v95
    v_add_f32 v92, v92, v96
    v_add_f32 v92, v92, v97
    v_add_f32 v92, v92, v98
    v_add_f32 v92, v92, v99
    v_mov_b32 v110, v92
    s_nop 1
    v_permlane16_swap_b32 v110, v92
    s_nop 1
    v_add_f32 v92, v92, v110
    v_mov_b32 v110, v92
    s_nop 1
    v_permlane32_swap_b32 v110, v92
    s_nop 1
    v_add_f32 v92, v92, v110
    v_mov_b32 v93, 0x3727c5ac
    v_fmac_f32 v93, 0x3ae38e39, v92
    v_rsq_f32 v94, v93
    s_nop 1
    v_permlane16_swap_b32 v100, v102
    v_permlane16_swap_b32 v101, v103
    s_nop 1
    v_lshlrev_b32 v112, 16, v100
    v_and_b32 v113, 0xffff0000, v100
    v_lshlrev_b32 v114, 16, v101
    v_and_b32 v115, 0xffff0000, v101
    v_lshlrev_b32 v116, 16, v102
    v_and_b32 v117, 0xffff0000, v102
    v_lshlrev_b32 v118, 16, v103
    v_and_b32 v119, 0xffff0000, v103
    s_waitcnt vmcnt(0)
    ds_read_b64_tr_b16 v[32:33], v5 offset:0
    ds_read_b64_tr_b16 v[34:35], v5 offset:1280
    ds_read_b64_tr_b16 v[36:37], v5 offset:32
    ds_read_b64_tr_b16 v[38:39], v5 offset:1312
    ds_read_b64_tr_b16 v[40:41], v5 offset:64
    ds_read_b64_tr_b16 v[42:43], v5 offset:1344
    ds_read_b64_tr_b16 v[44:45], v5 offset:96
    ds_read_b64_tr_b16 v[46:47], v5 offset:1376
    ds_read_b64_tr_b16 v[48:49], v5 offset:128
    ds_read_b64_tr_b16 v[50:51], v5 offset:1408
    ds_read_b64_tr_b16 v[52:53], v5 offset:5120
    ds_read_b64_tr_b16 v[54:55], v5 offset:6400
    ds_read_b64_tr_b16 v[56:57], v5 offset:5152
    ds_read_b64_tr_b16 v[58:59], v5 offset:6432
    ds_read_b64_tr_b16 v[60:61], v5 offset:5184
    ds_read_b64_tr_b16 v[62:63], v5 offset:6464
    ds_read_b64_tr_b16 v[64:65], v5 offset:5216
    ds_read_b64_tr_b16 v[66:67], v5 offset:6496
    ds_read_b64_tr_b16 v[68:69], v5 offset:5248
    ds_read_b64_tr_b16 v[70:71], v5 offset:6528
    s_waitcnt lgkmcnt(10)
    v_mfma_f32_16x16x32_bf16 v[72:75], v[32:35], v[8:11], 0
    v_mfma_f32_16x16x32_bf16 v[76:79], v[36:39], v[8:11], 0
    v_mfma_f32_16x16x32_bf16 v[80:83], v[40:43], v[8:11], 0
    v_mfma_f32_16x16x32_bf16 v[84:87], v[44:47], v[8:11], 0
    v_mfma_f32_16x16x32_bf16 v[88:91], v[48:51], v[8:11], 0
    ds_read_b64_tr_b16 v[32:33], v5 offset:10240
    ds_read_b64_tr_b16 v[34:35], v5 offset:11520
    ds_read_b64_tr_b16 v[36:37], v5 offset:10272
    ds_read_b64_tr_b16 v[38:39], v5 offset:11552
    ds_read_b64_tr_b16 v[40:41], v5 offset:10304
    ds_read_b64_tr_b16 v[42:43], v5 offset:11584
    ds_read_b64_tr_b16 v[44:45], v5 offset:10336
    ds_read_b64_tr_b16 v[46:47], v5 offset:11616
    ds_read_b64_tr_b16 v[48:49], v5 offset:10368
    ds_read_b64_tr_b16 v[50:51], v5 offset:11648
    s_waitcnt lgkmcnt(10)
    v_mfma_f32_16x16x32_bf16 v[72:75], v[52:55], v[12:15], v[72:75]
    v_mfma_f32_16x16x32_bf16 v[76:79], v[56:59], v[12:15], v[76:79]
    v_mfma_f32_16x16x32_bf16 v[80:83], v[60:63], v[12:15], v[80:83]
    v_mfma_f32_16x16x32_bf16 v[84:87], v[64:67], v[12:15], v[84:87]
    v_mfma_f32_16x16x32_bf16 v[88:91], v[68:71], v[12:15], v[88:91]
    ds_read_b64_tr_b16 v[52:53], v5 offset:15360
    ds_read_b64_tr_b16 v[54:55], v5 offset:16640
    ds_read_b64_tr_b16 v[56:57], v5 offset:15392
    ds_read_b64_tr_b16 v[58:59], v5 offset:16672
    ds_read_b64_tr_b16 v[60:61], v5 offset:15424
    ds_read_b64_tr_b16 v[62:63], v5 offset:16704
    ds_read_b64_tr_b16 v[64:65], v5 offset:15456
    ds_read_b64_tr_b16 v[66:67], v5 offset:16736
    ds_read_b64_tr_b16 v[68:69], v5 offset:15488
    ds_read_b64_tr_b16 v[70:71], v5 offset:16768
    s_waitcnt lgkmcnt(10)
    v_mfma_f32_16x16x32_bf16 v[72:75], v[32:35], v[16:19], v[72:75]
    v_mfma_f32_16x16x32_bf16 v[76:79], v[36:39], v[16:19], v[76:79]
    v_mfma_f32_16x16x32_bf16 v[80:83], v[40:43], v[16:19], v[80:83]
    v_mfma_f32_16x16x32_bf16 v[84:87], v[44:47], v[16:19], v[84:87]
    v_mfma_f32_16x16x32_bf16 v[88:91], v[48:51], v[16:19], v[88:91]
    ds_read_b64_tr_b16 v[32:33], v5 offset:20480
    ds_read_b64_tr_b16 v[34:35], v5 offset:21760
    ds_read_b64_tr_b16 v[36:37], v5 offset:20512
    ds_read_b64_tr_b16 v[38:39], v5 offset:21792
    ds_read_b64_tr_b16 v[40:41], v5 offset:20544
    ds_read_b64_tr_b16 v[42:43], v5 offset:21824
    ds_read_b64_tr_b16 v[44:45], v5 offset:20576
    ds_read_b64_tr_b16 v[46:47], v5 offset:21856
    ds_read_b64_tr_b16 v[48:49], v5 offset:20608
    ds_read_b64_tr_b16 v[50:51], v5 offset:21888
    s_waitcnt lgkmcnt(10)
    v_mfma_f32_16x16x32_bf16 v[72:75], v[52:55], v[20:23], v[72:75]
    v_mfma_f32_16x16x32_bf16 v[76:79], v[56:59], v[20:23], v[76:79]
    v_mfma_f32_16x16x32_bf16 v[80:83], v[60:63], v[20:23], v[80:83]
    v_mfma_f32_16x16x32_bf16 v[84:87], v[64:67], v[20:23], v[84:87]
    v_mfma_f32_16x16x32_bf16 v[88:91], v[68:71], v[20:23], v[88:91]
    ds_read_b64_tr_b16 v[52:53], v5 offset:25600
    ds_read_b64_tr_b16 v[54:55], v5 offset:26880
    ds_read_b64_tr_b16 v[56:57], v5 offset:25632
    ds_read_b64_tr_b16 v[58:59], v5 offset:26912
    ds_read_b64_tr_b16 v[60:61], v5 offset:25664
    ds_read_b64_tr_b16 v[62:63], v5 offset:26944
    ds_read_b64_tr_b16 v[64:65], v5 offset:25696
    ds_read_b64_tr_b16 v[66:67], v5 offset:26976
    ds_read_b64_tr_b16 v[68:69], v5 offset:25728
    ds_read_b64_tr_b16 v[70:71], v5 offset:27008
    s_waitcnt lgkmcnt(10)
    v_mfma_f32_16x16x32_bf16 v[72:75], v[32:35], v[24:27], v[72:75]
    v_mfma_f32_16x16x32_bf16 v[76:79], v[36:39], v[24:27], v[76:79]
    v_mfma_f32_16x16x32_bf16 v[80:83], v[40:43], v[24:27], v[80:83]
    v_mfma_f32_16x16x32_bf16 v[84:87], v[44:47], v[24:27], v[84:87]
    v_mfma_f32_16x16x32_bf16 v[88:91], v[48:51], v[24:27], v[88:91]
    s_waitcnt lgkmcnt(0)
    v_mfma_f32_16x16x32_bf16 v[72:75], v[52:55], v[28:31], v[72:75]
    v_mfma_f32_16x16x32_bf16 v[76:79], v[56:59], v[28:31], v[76:79]
    v_mfma_f32_16x16x32_bf16 v[80:83], v[60:63], v[28:31], v[80:83]
    v_mfma_f32_16x16x32_bf16 v[84:87], v[64:67], v[28:31], v[84:87]
    v_mfma_f32_16x16x32_bf16 v[88:91], v[68:71], v[28:31], v[88:91]
    s_mov_b32 s38, s20
    s_mov_b32 s39, s21
    s_cmp_ge_u32 s22, 6
    s_cbranch_scc1 mega_wt28
    s_and_b32 s21, s2, 7
    s_lshr_b32 s23, s2, 3
    s_lshr_b32 s20, s21, 2
    s_lshl_b32 s20, s20, 4
    s_and_b32 s19, s23, 15
    s_add_u32 s20, s20, s19
    s_and_b32 s21, s21, 3
    s_lshl_b32 s21, s21, 1
    s_lshr_b32 s23, s23, 4
    s_add_u32 s21, s21, s23
    s_mov_b32 s8, s4
    s_mov_b32 s9, s5
    s_mov_b32 s10, 0xa20000
    s_mov_b32 s11, 0x20000
    v_and_b32 v120, 63, v0
    v_mul_u32_u24 v121, 2428, v120
    v_lshrrev_b32 v121, 16, v121
    v_mul_u32_u24 v122, 27, v121
    v_sub_u32 v122, v120, v122
    s_mul_i32 s23, s22, 2
    v_add_u32 v121, s23, v121
    v_mul_u32_u24 v121, 110592, v121
    v_lshl_add_u32 v121, v122, 7, v121
    s_mul_i32 s23, s21, 1327104
    s_mul_i32 s19, s19, 3456
    s_add_u32 s23, s23, s19
    s_add_u32 s23, s23, 0
    v_cmp_gt_u32 vcc, 54, v120
    s_and_saveexec_b64 s[18:19], vcc
    buffer_load_dword v162, v121, s[8:11], s23 offen
    s_mov_b64 exec, -1
mega_wt28:
    s_mov_b32 s20, s38
    s_mov_b32 s21, s39
    s_mul_i32 s40, s22, 5120
    s_add_u32 s40, s40, 97280
    v_add_u32 v5, s40, v2
    s_nop 7
    ds_write_b128 v5, v[72:75] offset:0
    ds_write_b128 v5, v[76:79] offset:1024
    ds_write_b128 v5, v[80:83] offset:2048
    ds_write_b128 v5, v[84:87] offset:3072
    ds_write_b128 v5, v[88:91] offset:4096
    s_waitcnt lgkmcnt(0)
    s_barrier
    s_mul_i32 s32, s24, 5120
    s_lshl_b32 s33, s25, 11
    s_add_u32 s33, s32, s33
    s_add_u32 s33, s33, 97280
    v_add_u32 v5, s33, v2
    s_mul_i32 s32, s24, 5120
    s_add_u32 s32, s32, 101888
    v_lshlrev_b32 v110, 4, v3
    v_add_u32 v110, s32, v110
    ds_read_b64 v[72:73], v110 offset:0
    ds_read_b64 v[74:75], v110 offset:20480
    ds_read_b64 v[76:77], v110 offset:40960
    ds_read_b128 v[32:35], v5 offset:0
    ds_read_b128 v[36:39], v5 offset:20480
    ds_read_b128 v[40:43], v5 offset:40960
    ds_read_b128 v[44:47], v5 offset:1024
    ds_read_b128 v[48:51], v5 offset:21504
    ds_read_b128 v[52:55], v5 offset:41984
    s_waitcnt lgkmcnt(6)
    v_add_f32 v72, v72, v73
    v_add_f32 v74, v74, v75
    v_add_f32 v76, v76, v77
    v_add_f32 v72, v72, v74
    v_add_f32 v72, v72, v76
    v_mov_b32 v78, 0
    s_waitcnt lgkmcnt(0)
    v_add_f32 v32, v32, v36
    v_add_f32 v33, v33, v37
    v_add_f32 v34, v34, v38
    v_add_f32 v35, v35, v39
    v_add_f32 v32, v32, v40
    v_add_f32 v33, v33, v41
    v_add_f32 v34, v34, v42
    v_add_f32 v35, v35, v43
    v_fmac_f32 v32, v112, v94
    v_fmac_f32 v33, v113, v94
    v_fmac_f32 v34, v114, v94
    v_fmac_f32 v35, v115, v94
    v_add_f32 v112, v112, v104
    v_add_f32 v113, v113, v104
    v_add_f32 v114, v114, v104
    v_add_f32 v115, v115, v104
    v_add_f32 v112, v112, v32
    v_add_f32 v113, v113, v33
    v_add_f32 v114, v114, v34
    v_add_f32 v115, v115, v35
    v_sub_f32 v32, v32, v72
    v_sub_f32 v33, v33, v72
    v_sub_f32 v34, v34, v72
    v_sub_f32 v35, v35, v72
    v_add_f32 v44, v44, v48
    v_add_f32 v45, v45, v49
    v_add_f32 v46, v46, v50
    v_add_f32 v47, v47, v51
    v_add_f32 v44, v44, v52
    v_add_f32 v45, v45, v53
    v_add_f32 v46, v46, v54
    v_add_f32 v47, v47, v55
    v_fmac_f32 v44, v116, v94
    v_fmac_f32 v45, v117, v94
    v_fmac_f32 v46, v118, v94
    v_fmac_f32 v47, v119, v94
    v_add_f32 v116, v116, v104
    v_add_f32 v117, v117, v104
    v_add_f32 v118, v118, v104
    v_add_f32 v119, v119, v104
    v_add_f32 v116, v116, v44
    v_add_f32 v117, v117, v45
    v_add_f32 v118, v118, v46
    v_add_f32 v119, v119, v47
    v_sub_f32 v44, v44, v72
    v_sub_f32 v45, v45, v72
    v_sub_f32 v46, v46, v72
    v_sub_f32 v47, v47, v72
    s_cmp_eq_u32 s25, 2
    s_cbranch_scc1 mega_D25_q2
    v_fmac_f32 v78, v32, v32
    v_fmac_f32 v78, v33, v33
    v_fmac_f32 v78, v34, v34
    v_fmac_f32 v78, v35, v35
    v_fmac_f32 v78, v44, v44
    v_fmac_f32 v78, v45, v45
    v_fmac_f32 v78, v46, v46
    v_fmac_f32 v78, v47, v47
    s_branch mega_D25_q3
mega_D25_q2:
    s_mov_b32 exec_lo, 0xffffffff
    s_mov_b32 exec_hi, 0x0
    v_fmac_f32 v78, v32, v32
    v_fmac_f32 v78, v33, v33
    v_fmac_f32 v78, v34, v34
    v_fmac_f32 v78, v35, v35
    s_mov_b64 exec, -1
mega_D25_q3:
    v_cvt_pk_bf16_f32 v80, v32, v33
    v_cvt_pk_bf16_f32 v81, v34, v35
    v_cvt_pk_bf16_f32 v82, v44, v45
    v_cvt_pk_bf16_f32 v83, v46, v47
    v_cvt_pk_bf16_f32 v84, v112, v113
    v_cvt_pk_bf16_f32 v85, v114, v115
    v_cvt_pk_bf16_f32 v86, v116, v117
    v_cvt_pk_bf16_f32 v87, v118, v119
    s_nop 1
    v_permlane16_swap_b32 v80, v82
    v_permlane16_swap_b32 v81, v83
    s_nop 1
    s_nop 1
    v_permlane16_swap_b32 v84, v86
    v_permlane16_swap_b32 v85, v87
    s_nop 1
    s_cmp_eq_u32 s25, 2
    s_cbranch_scc0 mega_D25_om
    s_mov_b32 exec_lo, 0xffff
    s_mov_b32 exec_hi, 0x0
mega_D25_om:
    buffer_store_dwordx4 v[80:83], v7, s[44:47], s36 offen sc1
    buffer_store_dwordx4 v[84:87], v7, s[48:51], s36 offen sc1
    s_mov_b64 exec, -1
    v_mov_b32 v110, v78
    s_nop 1
    v_permlane16_swap_b32 v110, v78
    s_nop 1
    v_add_f32 v78, v78, v110
    v_mov_b32 v110, v78
    s_nop 1
    v_permlane32_swap_b32 v110, v78
    s_nop 1
    v_add_f32 v78, v78, v110
    s_mul_i32 s33, s21, 3
    s_add_u32 s33, s33, s25
    s_lshl_b32 s33, s33, 2
    v_add_u32 v110, s30, v3
    v_lshlrev_b32 v110, 7, v110
    v_add_u32 v110, s33, v110
    s_mov_b32 exec_lo, 0xffff
    s_mov_b32 exec_hi, 0x0
    buffer_store_dword v78, v110, s[52:55], 0 offen sc1
    s_mov_b64 exec, -1
    s_waitcnt vmcnt(0)
    s_barrier
    s_cmp_lg_u32 s22, 0
    s_cbranch_scc1 mega_sg29
    s_add_u32 s82, s20, 64
    s_lshl_b32 s82, s82, 7
    v_mov_b32 v110, s82
    v_mov_b32 v111, 1
    s_mov_b64 exec, 1
    buffer_atomic_add v111, v110, s[84:87], 0 offen sc1
mega_sg29:
    s_mov_b64 exec, -1
    v_and_b32 v1, 63, v0
    v_lshlrev_b32 v2, 4, v1
    v_and_b32 v3, 15, v1
    v_lshrrev_b32 v4, 4, v1
    s_and_b32 s21, s2, 7
    s_lshr_b32 s23, s2, 3
    s_lshr_b32 s20, s21, 2
    s_lshl_b32 s20, s20, 4
    s_and_b32 s19, s23, 15
    s_add_u32 s20, s20, s19
    s_and_b32 s21, s21, 3
    s_lshl_b32 s21, s21, 1
    s_lshr_b32 s23, s23, 4
    s_add_u32 s21, s21, s23
    s_mul_i32 s31, s21, 12
    s_add_u32 s31, s31, s22
    s_mul_i32 s31, s31, 110592
    s_mov_b32 s12, s4
    s_mov_b32 s13, s5
    s_mov_b32 s14, 0xa20000
    s_mov_b32 s15, 0x20000
    buffer_load_dwordx4 v[84:87], v2, s[12:15], s31 offen offset:0
    buffer_load_dwordx4 v[88:91], v2, s[12:15], s31 offen offset:1024
    buffer_load_dwordx4 v[92:95], v2, s[12:15], s31 offen offset:2048
    s_add_u32 s31, s31, 3072
    buffer_load_dwordx4 v[96:99], v2, s[12:15], s31 offen offset:0
    buffer_load_dwordx4 v[100:103], v2, s[12:15], s31 offen offset:1024
    buffer_load_dwordx4 v[104:107], v2, s[12:15], s31 offen offset:2048
    s_add_u32 s31, s31, 3072
    buffer_load_dwordx4 v[108:111], v2, s[12:15], s31 offen offset:0
    buffer_load_dwordx4 v[112:115], v2, s[12:15], s31 offen offset:1024
    buffer_load_dwordx4 v[116:119], v2, s[12:15], s31 offen offset:2048
    s_add_u32 s31, s31, 3072
    s_add_u32 s33, s20, 64
    s_cmp_lg_u32 s22, 0
    s_cbranch_scc1 mega_wc31
    v_and_b32 v1, 63, v0
    v_add_u32 v2, s33, v1
    v_lshlrev_b32 v1, 7, v2
    s_mov_b32 exec_lo, 0x1
    s_mov_b32 exec_hi, 0x0
    s_mov_b32 s82, 0
mega_pl32:
    buffer_load_dword v2, v1, s[84:87], 0 offen sc1
    s_waitcnt vmcnt(0)
    v_cmp_gt_u32 vcc, 8, v2
    s_add_u32 s82, s82, 1
    s_cmp_gt_u32 s82, 400000
    s_cbranch_scc1 mega_pl32_x
    s_cbranch_vccz mega_pl32_x
    s_sleep 1
    s_branch mega_pl32
mega_pl32_x:
    s_mov_b64 exec, -1
mega_wc31:
    s_barrier
    v_and_b32 v1, 63, v0
    v_lshlrev_b32 v2, 4, v1
    v_and_b32 v3, 15, v1
    v_lshrrev_b32 v4, 4, v1
    s_cmp_lg_u32 s22, 4
    s_cbranch_scc1 mega_E30_noz
    v_lshlrev_b32 v5, 2, v1
    v_add_u32 v5, 148480, v5
    v_mov_b32 v6, 0
    ds_write_b32 v5, v6
mega_E30_noz:
    s_mul_i32 s28, s20, 73728
    s_mul_i32 s29, s22, 6144
    s_add_u32 s28, s28, s29
    s_mov_b32 m0, s29
    s_add_u32 s8, s4, 0xa20000
    s_addc_u32 s9, s5, 0
    s_mov_b32 s10, 0x240000
    s_mov_b32 s11, 0x20000
    buffer_load_dwordx4 v2, s[8:11], s28 offen offset:0 sc1 lds
    buffer_load_dwordx4 v2, s[8:11], s28 offen offset:1024 sc1 lds
    buffer_load_dwordx4 v2, s[8:11], s28 offen offset:2048 sc1 lds
    buffer_load_dwordx4 v2, s[8:11], s28 offen offset:3072 sc1 lds
    s_add_u32 m0, s29, 4096
    s_add_u32 s28, s28, 4096
    s_nop 0
    buffer_load_dwordx4 v2, s[8:11], s28 offen offset:0 sc1 lds
    buffer_load_dwordx4 v2, s[8:11], s28 offen offset:1024 sc1 lds
    s_add_u32 s16, s4, 0xea0000
    s_addc_u32 s17, s5, 0
    s_mov_b32 s18, 0x40000
    s_mov_b32 s19, 0x20000
    s_cmp_ge_u32 s22, 4
    s_cbranch_scc1 mega_E30_noss
    s_lshl_b32 s30, s20, 6
    s_lshl_b32 s33, s22, 4
    s_add_u32 s30, s30, s33
    v_add_u32 v5, s30, v3
    v_lshlrev_b32 v5, 7, v5
    v_lshl_add_u32 v5, v4, 5, v5
    v_cmp_eq_u32 vcc, 3, v4
    v_mov_b32 v6, 0x7fffff00
    s_nop 0
    v_cndmask_b32 v5, v5, v6, vcc
    buffer_load_dwordx4 v[36:39], v5, s[16:19], 0 offen sc1
    buffer_load_dwordx4 v[40:43], v5, s[16:19], 0 offen offset:16 sc1
    s_waitcnt vmcnt(0)
    v_add_f32 v36, v36, v37
    v_add_f32 v36, v36, v38
    v_add_f32 v36, v36, v39
    v_add_f32 v36, v36, v40
    v_add_f32 v36, v36, v41
    v_add_f32 v36, v36, v42
    v_add_f32 v36, v36, v43
    v_mov_b32 v44, v36
    s_nop 1
    v_permlane16_swap_b32 v44, v36
    s_nop 1
    v_add_f32 v36, v36, v44
    v_mov_b32 v44, v36
    s_nop 1
    v_permlane32_swap_b32 v44, v36
    s_nop 1
    v_add_f32 v36, v36, v44
    v_mov_b32 v37, 0x3727c5ac
    v_fmac_f32 v37, 0x3ae38e39, v36
    v_rsq_f32 v38, v37
    s_nop 0
    v_mul_f32 v10, v37, v38
    v_mul_f32 v8, 0xc0135761, v38
    v_mul_f32 v39, v38, v38
    v_mul_f32 v39, v39, v38
    v_mul_f32 v9, 0xbdd2d3e8, v39
    s_lshl_b32 s33, s22, 8
    v_lshlrev_b32 v5, 4, v3
    v_add_u32 v5, s33, v5
    v_add_u32 v5, 147456, v5
    ds_write_b96 v5, v[8:10]
mega_E30_noss:
    s_add_u32 s24, s4, 0xee0000
    s_addc_u32 s25, s5, 0
    s_mov_b32 s26, 0x1200000
    s_mov_b32 s27, 0x20000
    s_mul_i32 s32, s22, 3
    s_waitcnt vmcnt(0) lgkmcnt(0)
    s_barrier
    v_lshlrev_b32 v5, 4, v3
    v_add_u32 v5, 147456, v5
    ds_read_b96 v[20:22], v5 offset:0
    ds_read_b96 v[24:26], v5 offset:256
    ds_read_b96 v[28:30], v5 offset:512
    ds_read_b96 v[32:34], v5 offset:768
    v_mov_b32 v36, 0
    v_mov_b32 v37, 0
    v_mov_b32 v38, 0
    v_mov_b32 v39, 0
    v_mov_b32 v40, 0
    v_mov_b32 v41, 0
    v_mov_b32 v42, 0
    v_mov_b32 v43, 0
    v_mov_b32 v44, 0
    v_mov_b32 v45, 0
    v_mov_b32 v46, 0
    v_mov_b32 v47, 0
    v_mov_b32 v48, 0
    v_mov_b32 v49, 0
    v_mov_b32 v50, 0
    v_mov_b32 v51, 0
    v_mov_b32 v52, 0
    v_mov_b32 v53, 0
    v_mov_b32 v54, 0
    v_mov_b32 v55, 0
    v_mov_b32 v56, 0
    v_mov_b32 v57, 0
    v_mov_b32 v58, 0
    v_mov_b32 v59, 0
    v_mov_b32 v60, 0
    v_mov_b32 v61, 0
    v_mov_b32 v62, 0
    v_mov_b32 v63, 0
    v_mov_b32 v64, 0
    v_mov_b32 v65, 0
    v_mov_b32 v66, 0
    v_mov_b32 v67, 0
    v_mov_b32 v68, 0
    v_mov_b32 v69, 0
    v_mov_b32 v70, 0
    v_mov_b32 v71, 0
    v_mov_b32 v72, 0
    v_mov_b32 v73, 0
    v_mov_b32 v74, 0
    v_mov_b32 v75, 0
    v_mov_b32 v76, 0
    v_mov_b32 v77, 0
    v_mov_b32 v78, 0
    v_mov_b32 v79, 0
    v_mov_b32 v80, 0
    v_mov_b32 v81, 0
    v_mov_b32 v82, 0
    v_mov_b32 v83, 0
    s_waitcnt lgkmcnt(0)
    v_mov_b32 v8, v20
    v_mov_b32 v9, v21
    v_mov_b32 v10, v22
    v_mov_b32 v11, v24
    v_mov_b32 v12, v25
    v_mov_b32 v13, v26
    v_mov_b32 v14, v28
    v_mov_b32 v15, v29
    v_mov_b32 v16, v30
    v_mov_b32 v17, v32
    v_mov_b32 v18, v33
    v_mov_b32 v19, v34
    s_mov_b32 s34, 0
    s_mov_b32 s35, 0
    v_mov_b32 v7, v2
    s_setprio 3
mega_E30_loop:
    ds_read_b128 v[20:23], v7 offset:0
    ds_read_b128 v[24:27], v7 offset:18432
    ds_read_b128 v[28:31], v7 offset:36864
    ds_read_b128 v[32:35], v7 offset:55296
    s_waitcnt vmcnt(6)
    s_waitcnt lgkmcnt(3)
    v_mfma_f32_16x16x32_bf16 v[36:39], v[84:87], v[20:23], v[36:39]
    v_mfma_f32_16x16x32_bf16 v[52:55], v[88:91], v[20:23], v[52:55]
    v_mfma_f32_16x16x32_bf16 v[68:71], v[92:95], v[20:23], v[68:71]
    ds_read_b128 v[20:23], v7 offset:1024
    s_waitcnt lgkmcnt(3)
    v_mfma_f32_16x16x32_bf16 v[40:43], v[84:87], v[24:27], v[40:43]
    v_mfma_f32_16x16x32_bf16 v[56:59], v[88:91], v[24:27], v[56:59]
    v_mfma_f32_16x16x32_bf16 v[72:75], v[92:95], v[24:27], v[72:75]
    ds_read_b128 v[24:27], v7 offset:19456
    s_waitcnt lgkmcnt(3)
    v_mfma_f32_16x16x32_bf16 v[44:47], v[84:87], v[28:31], v[44:47]
    v_mfma_f32_16x16x32_bf16 v[60:63], v[88:91], v[28:31], v[60:63]
    v_mfma_f32_16x16x32_bf16 v[76:79], v[92:95], v[28:31], v[76:79]
    ds_read_b128 v[28:31], v7 offset:37888
    s_waitcnt lgkmcnt(3)
    v_mfma_f32_16x16x32_bf16 v[48:51], v[84:87], v[32:35], v[48:51]
    v_mfma_f32_16x16x32_bf16 v[64:67], v[88:91], v[32:35], v[64:67]
    v_mfma_f32_16x16x32_bf16 v[80:83], v[92:95], v[32:35], v[80:83]
    ds_read_b128 v[32:35], v7 offset:56320
    buffer_load_dwordx4 v[84:87], v2, s[12:15], s31 offen offset:0
    buffer_load_dwordx4 v[88:91], v2, s[12:15], s31 offen offset:1024
    buffer_load_dwordx4 v[92:95], v2, s[12:15], s31 offen offset:2048
    s_add_u32 s31, s31, 3072
    s_waitcnt vmcnt(6)
    s_waitcnt lgkmcnt(3)
    v_mfma_f32_16x16x32_bf16 v[36:39], v[96:99], v[20:23], v[36:39]
    v_mfma_f32_16x16x32_bf16 v[52:55], v[100:103], v[20:23], v[52:55]
    v_mfma_f32_16x16x32_bf16 v[68:71], v[104:107], v[20:23], v[68:71]
    ds_read_b128 v[20:23], v7 offset:2048
    s_waitcnt lgkmcnt(3)
    v_mfma_f32_16x16x32_bf16 v[40:43], v[96:99], v[24:27], v[40:43]
    v_mfma_f32_16x16x32_bf16 v[56:59], v[100:103], v[24:27], v[56:59]
    v_mfma_f32_16x16x32_bf16 v[72:75], v[104:107], v[24:27], v[72:75]
    ds_read_b128 v[24:27], v7 offset:20480
    s_waitcnt lgkmcnt(3)
    v_mfma_f32_16x16x32_bf16 v[44:47], v[96:99], v[28:31], v[44:47]
    v_mfma_f32_16x16x32_bf16 v[60:63], v[100:103], v[28:31], v[60:63]
    v_mfma_f32_16x16x32_bf16 v[76:79], v[104:107], v[28:31], v[76:79]
    ds_read_b128 v[28:31], v7 offset:38912
    s_waitcnt lgkmcnt(3)
    v_mfma_f32_16x16x32_bf16 v[48:51], v[96:99], v[32:35], v[48:51]
    v_mfma_f32_16x16x32_bf16 v[64:67], v[100:103], v[32:35], v[64:67]
    v_mfma_f32_16x16x32_bf16 v[80:83], v[104:107], v[32:35], v[80:83]
    ds_read_b128 v[32:35], v7 offset:57344
    buffer_load_dwordx4 v[96:99], v2, s[12:15], s31 offen offset:0
    buffer_load_dwordx4 v[100:103], v2, s[12:15], s31 offen offset:1024
    buffer_load_dwordx4 v[104:107], v2, s[12:15], s31 offen offset:2048
    s_add_u32 s31, s31, 3072
    s_waitcnt vmcnt(6)
    s_waitcnt lgkmcnt(3)
    v_mfma_f32_16x16x32_bf16 v[36:39], v[108:111], v[20:23], v[36:39]
    v_mfma_f32_16x16x32_bf16 v[52:55], v[112:115], v[20:23], v[52:55]
    v_mfma_f32_16x16x32_bf16 v[68:71], v[116:119], v[20:23], v[68:71]
    ds_read_b128 v[20:23], v7 offset:3072
    s_waitcnt lgkmcnt(3)
    v_mfma_f32_16x16x32_bf16 v[40:43], v[108:111], v[24:27], v[40:43]
    v_mfma_f32_16x16x32_bf16 v[56:59], v[112:115], v[24:27], v[56:59]
    v_mfma_f32_16x16x32_bf16 v[72:75], v[116:119], v[24:27], v[72:75]
    ds_read_b128 v[24:27], v7 offset:21504
    s_waitcnt lgkmcnt(3)
    v_mfma_f32_16x16x32_bf16 v[44:47], v[108:111], v[28:31], v[44:47]
    v_mfma_f32_16x16x32_bf16 v[60:63], v[112:115], v[28:31], v[60:63]
    v_mfma_f32_16x16x32_bf16 v[76:79], v[116:119], v[28:31], v[76:79]
    ds_read_b128 v[28:31], v7 offset:39936
    s_waitcnt lgkmcnt(3)
    v_mfma_f32_16x16x32_bf16 v[48:51], v[108:111], v[32:35], v[48:51]
    v_mfma_f32_16x16x32_bf16 v[64:67], v[112:115], v[32:35], v[64:67]
    v_mfma_f32_16x16x32_bf16 v[80:83], v[116:119], v[32:35], v[80:83]
    ds_read_b128 v[32:35], v7 offset:58368
    buffer_load_dwordx4 v[108:111], v2, s[12:15], s31 offen offset:0
    buffer_load_dwordx4 v[112:115], v2, s[12:15], s31 offen offset:1024
    buffer_load_dwordx4 v[116:119], v2, s[12:15], s31 offen offset:2048
    s_add_u32 s31, s31, 3072
    s_waitcnt vmcnt(6)
    s_waitcnt lgkmcnt(3)
    v_mfma_f32_16x16x32_bf16 v[36:39], v[84:87], v[20:23], v[36:39]
    v_mfma_f32_16x16x32_bf16 v[52:55], v[88:91], v[20:23], v[52:55]
    v_mfma_f32_16x16x32_bf16 v[68:71], v[92:95], v[20:23], v[68:71]
    ds_read_b128 v[20:23], v7 offset:4096
    s_waitcnt lgkmcnt(3)
    v_mfma_f32_16x16x32_bf16 v[40:43], v[84:87], v[24:27], v[40:43]
    v_mfma_f32_16x16x32_bf16 v[56:59], v[88:91], v[24:27], v[56:59]
    v_mfma_f32_16x16x32_bf16 v[72:75], v[92:95], v[24:27], v[72:75]
    ds_read_b128 v[24:27], v7 offset:22528
    s_waitcnt lgkmcnt(3)
    v_mfma_f32_16x16x32_bf16 v[44:47], v[84:87], v[28:31], v[44:47]
    v_mfma_f32_16x16x32_bf16 v[60:63], v[88:91], v[28:31], v[60:63]
    v_mfma_f32_16x16x32_bf16 v[76:79], v[92:95], v[28:31], v[76:79]
    ds_read_b128 v[28:31], v7 offset:40960
    s_waitcnt lgkmcnt(3)
    v_mfma_f32_16x16x32_bf16 v[48:51], v[84:87], v[32:35], v[48:51]
    v_mfma_f32_16x16x32_bf16 v[64:67], v[88:91], v[32:35], v[64:67]
    v_mfma_f32_16x16x32_bf16 v[80:83], v[92:95], v[32:35], v[80:83]
    ds_read_b128 v[32:35], v7 offset:59392
    buffer_load_dwordx4 v[84:87], v2, s[12:15], s31 offen offset:0
    buffer_load_dwordx4 v[88:91], v2, s[12:15], s31 offen offset:1024
    buffer_load_dwordx4 v[92:95], v2, s[12:15], s31 offen offset:2048
    s_add_u32 s31, s31, 3072
    s_waitcnt vmcnt(6)
    s_waitcnt lgkmcnt(3)
    v_mfma_f32_16x16x32_bf16 v[36:39], v[96:99], v[20:23], v[36:39]
    v_mfma_f32_16x16x32_bf16 v[52:55], v[100:103], v[20:23], v[52:55]
    v_mfma_f32_16x16x32_bf16 v[68:71], v[104:107], v[20:23], v[68:71]
    ds_read_b128 v[20:23], v7 offset:5120
    s_waitcnt lgkmcnt(3)
    v_mfma_f32_16x16x32_bf16 v[40:43], v[96:99], v[24:27], v[40:43]
    v_mfma_f32_16x16x32_bf16 v[56:59], v[100:103], v[24:27], v[56:59]
    v_mfma_f32_16x16x32_bf16 v[72:75], v[104:107], v[24:27], v[72:75]
    ds_read_b128 v[24:27], v7 offset:23552
    s_waitcnt lgkmcnt(3)
    v_mfma_f32_16x16x32_bf16 v[44:47], v[96:99], v[28:31], v[44:47]
    v_mfma_f32_16x16x32_bf16 v[60:63], v[100:103], v[28:31], v[60:63]
    v_mfma_f32_16x16x32_bf16 v[76:79], v[104:107], v[28:31], v[76:79]
    ds_read_b128 v[28:31], v7 offset:41984
    s_waitcnt lgkmcnt(3)
    v_mfma_f32_16x16x32_bf16 v[48:51], v[96:99], v[32:35], v[48:51]
    v_mfma_f32_16x16x32_bf16 v[64:67], v[100:103], v[32:35], v[64:67]
    v_mfma_f32_16x16x32_bf16 v[80:83], v[104:107], v[32:35], v[80:83]
    ds_read_b128 v[32:35], v7 offset:60416
    buffer_load_dwordx4 v[96:99], v2, s[12:15], s31 offen offset:0
    buffer_load_dwordx4 v[100:103], v2, s[12:15], s31 offen offset:1024
    buffer_load_dwordx4 v[104:107], v2, s[12:15], s31 offen offset:2048
    s_add_u32 s31, s31, 3072
    s_waitcnt vmcnt(6)
    s_waitcnt lgkmcnt(3)
    v_mfma_f32_16x16x32_bf16 v[36:39], v[108:111], v[20:23], v[36:39]
    v_mfma_f32_16x16x32_bf16 v[52:55], v[112:115], v[20:23], v[52:55]
    v_mfma_f32_16x16x32_bf16 v[68:71], v[116:119], v[20:23], v[68:71]
    s_waitcnt lgkmcnt(2)
    v_mfma_f32_16x16x32_bf16 v[40:43], v[108:111], v[24:27], v[40:43]
    v_mfma_f32_16x16x32_bf16 v[56:59], v[112:115], v[24:27], v[56:59]
    v_mfma_f32_16x16x32_bf16 v[72:75], v[116:119], v[24:27], v[72:75]
    s_waitcnt lgkmcnt(1)
    v_mfma_f32_16x16x32_bf16 v[44:47], v[108:111], v[28:31], v[44:47]
    v_mfma_f32_16x16x32_bf16 v[60:63], v[112:115], v[28:31], v[60:63]
    v_mfma_f32_16x16x32_bf16 v[76:79], v[116:119], v[28:31], v[76:79]
    s_waitcnt lgkmcnt(0)
    v_mfma_f32_16x16x32_bf16 v[48:51], v[108:111], v[32:35], v[48:51]
    v_mfma_f32_16x16x32_bf16 v[64:67], v[112:115], v[32:35], v[64:67]
    v_mfma_f32_16x16x32_bf16 v[80:83], v[116:119], v[32:35], v[80:83]
    buffer_load_dwordx4 v[108:111], v2, s[12:15], s31 offen offset:0
    buffer_load_dwordx4 v[112:115], v2, s[12:15], s31 offen offset:1024
    buffer_load_dwordx4 v[116:119], v2, s[12:15], s31 offen offset:2048
    s_add_u32 s31, s31, 3072
    v_add_u32 v7, 6144, v7
    s_add_u32 s35, s35, 1
    s_cmp_eq_u32 s34, 0
    s_cbranch_scc0 mega_E30_p1next
    s_cmp_lt_u32 s35, 3
    s_cbranch_scc1 mega_E30_loop
    s_setprio 2
    s_nop 7
    v_lshrrev_b32 v4, 5, v1
    s_mul_i32 s36, s22, 6
    v_add_u32 v4, s36, v4
    v_lshlrev_b32 v4, 8, v4
    v_lshl_add_u32 v4, v3, 4, v4
    v_bfe_u32 v5, v1, 4, 1
    v_lshl_add_u32 v4, v5, 3, v4
    v_add_u32 v4, 73728, v4
    v_mul_f32 v20, v36, v36
    v_mul_f32 v21, v37, v37
    v_mul_f32 v22, v38, v38
    v_mul_f32 v23, v39, v39
    v_fma_f32 v20, v20, v9, v8
    v_fma_f32 v21, v21, v9, v8
    v_fma_f32 v22, v22, v9, v8
    v_fma_f32 v23, v23, v9, v8
    v_mul_f32 v20, v20, v36
    v_mul_f32 v21, v21, v37
    v_mul_f32 v22, v22, v38
    v_mul_f32 v23, v23, v39
    v_exp_f32 v20, v20
    v_exp_f32 v21, v21
    v_exp_f32 v22, v22
    v_exp_f32 v23, v23
    v_fma_f32 v20, v20, v10, v10
    v_fma_f32 v21, v21, v10, v10
    v_fma_f32 v22, v22, v10, v10
    v_fma_f32 v23, v23, v10, v10
    v_rcp_f32 v20, v20
    v_rcp_f32 v21, v21
    v_rcp_f32 v22, v22
    v_rcp_f32 v23, v23
    v_mul_f32 v20, v20, v36
    v_mul_f32 v21, v21, v37
    v_mul_f32 v22, v22, v38
    v_mul_f32 v23, v23, v39
    v_cvt_pk_bf16_f32 v20, v20, v21
    v_cvt_pk_bf16_f32 v21, v22, v23
    ds_write_b64 v4, v[20:21] offset:0
    v_mul_f32 v24, v40, v40
    v_mul_f32 v25, v41, v41
    v_mul_f32 v26, v42, v42
    v_mul_f32 v27, v43, v43
    v_fma_f32 v24, v24, v12, v11
    v_fma_f32 v25, v25, v12, v11
    v_fma_f32 v26, v26, v12, v11
    v_fma_f32 v27, v27, v12, v11
    v_mul_f32 v24, v24, v40
    v_mul_f32 v25, v25, v41
    v_mul_f32 v26, v26, v42
    v_mul_f32 v27, v27, v43
    v_exp_f32 v24, v24
    v_exp_f32 v25, v25
    v_exp_f32 v26, v26
    v_exp_f32 v27, v27
    v_fma_f32 v24, v24, v13, v13
    v_fma_f32 v25, v25, v13, v13
    v_fma_f32 v26, v26, v13, v13
    v_fma_f32 v27, v27, v13, v13
    v_rcp_f32 v24, v24
    v_rcp_f32 v25, v25
    v_rcp_f32 v26, v26
    v_rcp_f32 v27, v27
    v_mul_f32 v24, v24, v40
    v_mul_f32 v25, v25, v41
    v_mul_f32 v26, v26, v42
    v_mul_f32 v27, v27, v43
    v_cvt_pk_bf16_f32 v24, v24, v25
    v_cvt_pk_bf16_f32 v25, v26, v27
    ds_write_b64 v4, v[24:25] offset:18432
    v_mul_f32 v28, v44, v44
    v_mul_f32 v29, v45, v45
    v_mul_f32 v30, v46, v46
    v_mul_f32 v31, v47, v47
    v_fma_f32 v28, v28, v15, v14
    v_fma_f32 v29, v29, v15, v14
    v_fma_f32 v30, v30, v15, v14
    v_fma_f32 v31, v31, v15, v14
    v_mul_f32 v28, v28, v44
    v_mul_f32 v29, v29, v45
    v_mul_f32 v30, v30, v46
    v_mul_f32 v31, v31, v47
    v_exp_f32 v28, v28
    v_exp_f32 v29, v29
    v_exp_f32 v30, v30
    v_exp_f32 v31, v31
    v_fma_f32 v28, v28, v16, v16
    v_fma_f32 v29, v29, v16, v16
    v_fma_f32 v30, v30, v16, v16
    v_fma_f32 v31, v31, v16, v16
    v_rcp_f32 v28, v28
    v_rcp_f32 v29, v29
    v_rcp_f32 v30, v30
    v_rcp_f32 v31, v31
    v_mul_f32 v28, v28, v44
    v_mul_f32 v29, v29, v45
    v_mul_f32 v30, v30, v46
    v_mul_f32 v31, v31, v47
    v_cvt_pk_bf16_f32 v28, v28, v29
    v_cvt_pk_bf16_f32 v29, v30, v31
    ds_write_b64 v4, v[28:29] offset:36864
    v_mul_f32 v32, v48, v48
    v_mul_f32 v33, v49, v49
    v_mul_f32 v34, v50, v50
    v_mul_f32 v35, v51, v51
    v_fma_f32 v32, v32, v18, v17
    v_fma_f32 v33, v33, v18, v17
    v_fma_f32 v34, v34, v18, v17
    v_fma_f32 v35, v35, v18, v17
    v_mul_f32 v32, v32, v48
    v_mul_f32 v33, v33, v49
    v_mul_f32 v34, v34, v50
    v_mul_f32 v35, v35, v51
    v_exp_f32 v32, v32
    v_exp_f32 v33, v33
    v_exp_f32 v34, v34
    v_exp_f32 v35, v35
    v_fma_f32 v32, v32, v19, v19
    v_fma_f32 v33, v33, v19, v19
    v_fma_f32 v34, v34, v19, v19
    v_fma_f32 v35, v35, v19, v19
    v_rcp_f32 v32, v32
    v_rcp_f32 v33, v33
    v_rcp_f32 v34, v34
    v_rcp_f32 v35, v35
    v_mul_f32 v32, v32, v48
    v_mul_f32 v33, v33, v49
    v_mul_f32 v34, v34, v50
    v_mul_f32 v35, v35, v51
    v_cvt_pk_bf16_f32 v32, v32, v33
    v_cvt_pk_bf16_f32 v33, v34, v35
    ds_write_b64 v4, v[32:33] offset:55296
    v_mul_f32 v20, v52, v52
    v_mul_f32 v21, v53, v53
    v_mul_f32 v22, v54, v54
    v_mul_f32 v23, v55, v55
    v_fma_f32 v20, v20, v9, v8
    v_fma_f32 v21, v21, v9, v8
    v_fma_f32 v22, v22, v9, v8
    v_fma_f32 v23, v23, v9, v8
    v_mul_f32 v20, v20, v52
    v_mul_f32 v21, v21, v53
    v_mul_f32 v22, v22, v54
    v_mul_f32 v23, v23, v55
    v_exp_f32 v20, v20
    v_exp_f32 v21, v21
    v_exp_f32 v22, v22
    v_exp_f32 v23, v23
    v_fma_f32 v20, v20, v10, v10
    v_fma_f32 v21, v21, v10, v10
    v_fma_f32 v22, v22, v10, v10
    v_fma_f32 v23, v23, v10, v10
    v_rcp_f32 v20, v20
    v_rcp_f32 v21, v21
    v_rcp_f32 v22, v22
    v_rcp_f32 v23, v23
    v_mul_f32 v20, v20, v52
    v_mul_f32 v21, v21, v53
    v_mul_f32 v22, v22, v54
    v_mul_f32 v23, v23, v55
    v_cvt_pk_bf16_f32 v20, v20, v21
    v_cvt_pk_bf16_f32 v21, v22, v23
    ds_write_b64 v4, v[20:21] offset:512
    v_mul_f32 v24, v56, v56
    v_mul_f32 v25, v57, v57
    v_mul_f32 v26, v58, v58
    v_mul_f32 v27, v59, v59
    v_fma_f32 v24, v24, v12, v11
    v_fma_f32 v25, v25, v12, v11
    v_fma_f32 v26, v26, v12, v11
    v_fma_f32 v27, v27, v12, v11
    v_mul_f32 v24, v24, v56
    v_mul_f32 v25, v25, v57
    v_mul_f32 v26, v26, v58
    v_mul_f32 v27, v27, v59
    v_exp_f32 v24, v24
    v_exp_f32 v25, v25
    v_exp_f32 v26, v26
    v_exp_f32 v27, v27
    v_fma_f32 v24, v24, v13, v13
    v_fma_f32 v25, v25, v13, v13
    v_fma_f32 v26, v26, v13, v13
    v_fma_f32 v27, v27, v13, v13
    v_rcp_f32 v24, v24
    v_rcp_f32 v25, v25
    v_rcp_f32 v26, v26
    v_rcp_f32 v27, v27
    v_mul_f32 v24, v24, v56
    v_mul_f32 v25, v25, v57
    v_mul_f32 v26, v26, v58
    v_mul_f32 v27, v27, v59
    v_cvt_pk_bf16_f32 v24, v24, v25
    v_cvt_pk_bf16_f32 v25, v26, v27
    ds_write_b64 v4, v[24:25] offset:18944
    v_mul_f32 v28, v60, v60
    v_mul_f32 v29, v61, v61
    v_mul_f32 v30, v62, v62
    v_mul_f32 v31, v63, v63
    v_fma_f32 v28, v28, v15, v14
    v_fma_f32 v29, v29, v15, v14
    v_fma_f32 v30, v30, v15, v14
    v_fma_f32 v31, v31, v15, v14
    v_mul_f32 v28, v28, v60
    v_mul_f32 v29, v29, v61
    v_mul_f32 v30, v30, v62
    v_mul_f32 v31, v31, v63
    v_exp_f32 v28, v28
    v_exp_f32 v29, v29
    v_exp_f32 v30, v30
    v_exp_f32 v31, v31
    v_fma_f32 v28, v28, v16, v16
    v_fma_f32 v29, v29, v16, v16
    v_fma_f32 v30, v30, v16, v16
    v_fma_f32 v31, v31, v16, v16
    v_rcp_f32 v28, v28
    v_rcp_f32 v29, v29
    v_rcp_f32 v30, v30
    v_rcp_f32 v31, v31
    v_mul_f32 v28, v28, v60
    v_mul_f32 v29, v29, v61
    v_mul_f32 v30, v30, v62
    v_mul_f32 v31, v31, v63
    v_cvt_pk_bf16_f32 v28, v28, v29
    v_cvt_pk_bf16_f32 v29, v30, v31
    ds_write_b64 v4, v[28:29] offset:37376
    v_mul_f32 v32, v64, v64
    v_mul_f32 v33, v65, v65
    v_mul_f32 v34, v66, v66
    v_mul_f32 v35, v67, v67
    v_fma_f32 v32, v32, v18, v17
    v_fma_f32 v33, v33, v18, v17
    v_fma_f32 v34, v34, v18, v17
    v_fma_f32 v35, v35, v18, v17
    v_mul_f32 v32, v32, v64
    v_mul_f32 v33, v33, v65
    v_mul_f32 v34, v34, v66
    v_mul_f32 v35, v35, v67
    v_exp_f32 v32, v32
    v_exp_f32 v33, v33
    v_exp_f32 v34, v34
    v_exp_f32 v35, v35
    v_fma_f32 v32, v32, v19, v19
    v_fma_f32 v33, v33, v19, v19
    v_fma_f32 v34, v34, v19, v19
    v_fma_f32 v35, v35, v19, v19
    v_rcp_f32 v32, v32
    v_rcp_f32 v33, v33
    v_rcp_f32 v34, v34
    v_rcp_f32 v35, v35
    v_mul_f32 v32, v32, v64
    v_mul_f32 v33, v33, v65
    v_mul_f32 v34, v34, v66
    v_mul_f32 v35, v35, v67
    v_cvt_pk_bf16_f32 v32, v32, v33
    v_cvt_pk_bf16_f32 v33, v34, v35
    ds_write_b64 v4, v[32:33] offset:55808
    v_mul_f32 v20, v68, v68
    v_mul_f32 v21, v69, v69
    v_mul_f32 v22, v70, v70
    v_mul_f32 v23, v71, v71
    v_fma_f32 v20, v20, v9, v8
    v_fma_f32 v21, v21, v9, v8
    v_fma_f32 v22, v22, v9, v8
    v_fma_f32 v23, v23, v9, v8
    v_mul_f32 v20, v20, v68
    v_mul_f32 v21, v21, v69
    v_mul_f32 v22, v22, v70
    v_mul_f32 v23, v23, v71
    v_exp_f32 v20, v20
    v_exp_f32 v21, v21
    v_exp_f32 v22, v22
    v_exp_f32 v23, v23
    v_fma_f32 v20, v20, v10, v10
    v_fma_f32 v21, v21, v10, v10
    v_fma_f32 v22, v22, v10, v10
    v_fma_f32 v23, v23, v10, v10
    v_rcp_f32 v20, v20
    v_rcp_f32 v21, v21
    v_rcp_f32 v22, v22
    v_rcp_f32 v23, v23
    v_mul_f32 v20, v20, v68
    v_mul_f32 v21, v21, v69
    v_mul_f32 v22, v22, v70
    v_mul_f32 v23, v23, v71
    v_cvt_pk_bf16_f32 v20, v20, v21
    v_cvt_pk_bf16_f32 v21, v22, v23
    ds_write_b64 v4, v[20:21] offset:1024
    v_mul_f32 v24, v72, v72
    v_mul_f32 v25, v73, v73
    v_mul_f32 v26, v74, v74
    v_mul_f32 v27, v75, v75
    v_fma_f32 v24, v24, v12, v11
    v_fma_f32 v25, v25, v12, v11
    v_fma_f32 v26, v26, v12, v11
    v_fma_f32 v27, v27, v12, v11
    v_mul_f32 v24, v24, v72
    v_mul_f32 v25, v25, v73
    v_mul_f32 v26, v26, v74
    v_mul_f32 v27, v27, v75
    v_exp_f32 v24, v24
    v_exp_f32 v25, v25
    v_exp_f32 v26, v26
    v_exp_f32 v27, v27
    v_fma_f32 v24, v24, v13, v13
    v_fma_f32 v25, v25, v13, v13
    v_fma_f32 v26, v26, v13, v13
    v_fma_f32 v27, v27, v13, v13
    v_rcp_f32 v24, v24
    v_rcp_f32 v25, v25
    v_rcp_f32 v26, v26
    v_rcp_f32 v27, v27
    v_mul_f32 v24, v24, v72
    v_mul_f32 v25, v25, v73
    v_mul_f32 v26, v26, v74
    v_mul_f32 v27, v27, v75
    v_cvt_pk_bf16_f32 v24, v24, v25
    v_cvt_pk_bf16_f32 v25, v26, v27
    ds_write_b64 v4, v[24:25] offset:19456
    v_mul_f32 v28, v76, v76
    v_mul_f32 v29, v77, v77
    v_mul_f32 v30, v78, v78
    v_mul_f32 v31, v79, v79
    v_fma_f32 v28, v28, v15, v14
    v_fma_f32 v29, v29, v15, v14
    v_fma_f32 v30, v30, v15, v14
    v_fma_f32 v31, v31, v15, v14
    v_mul_f32 v28, v28, v76
    v_mul_f32 v29, v29, v77
    v_mul_f32 v30, v30, v78
    v_mul_f32 v31, v31, v79
    v_exp_f32 v28, v28
    v_exp_f32 v29, v29
    v_exp_f32 v30, v30
    v_exp_f32 v31, v31
    v_fma_f32 v28, v28, v16, v16
    v_fma_f32 v29, v29, v16, v16
    v_fma_f32 v30, v30, v16, v16
    v_fma_f32 v31, v31, v16, v16
    v_rcp_f32 v28, v28
    v_rcp_f32 v29, v29
    v_rcp_f32 v30, v30
    v_rcp_f32 v31, v31
    v_mul_f32 v28, v28, v76
    v_mul_f32 v29, v29, v77
    v_mul_f32 v30, v30, v78
    v_mul_f32 v31, v31, v79
    v_cvt_pk_bf16_f32 v28, v28, v29
    v_cvt_pk_bf16_f32 v29, v30, v31
    ds_write_b64 v4, v[28:29] offset:37888
    v_mul_f32 v32, v80, v80
    v_mul_f32 v33, v81, v81
    v_mul_f32 v34, v82, v82
    v_mul_f32 v35, v83, v83
    v_fma_f32 v32, v32, v18, v17
    v_fma_f32 v33, v33, v18, v17
    v_fma_f32 v34, v34, v18, v17
    v_fma_f32 v35, v35, v18, v17
    v_mul_f32 v32, v32, v80
    v_mul_f32 v33, v33, v81
    v_mul_f32 v34, v34, v82
    v_mul_f32 v35, v35, v83
    v_exp_f32 v32, v32
    v_exp_f32 v33, v33
    v_exp_f32 v34, v34
    v_exp_f32 v35, v35
    v_fma_f32 v32, v32, v19, v19
    v_fma_f32 v33, v33, v19, v19
    v_fma_f32 v34, v34, v19, v19
    v_fma_f32 v35, v35, v19, v19
    v_rcp_f32 v32, v32
    v_rcp_f32 v33, v33
    v_rcp_f32 v34, v34
    v_rcp_f32 v35, v35
    v_mul_f32 v32, v32, v80
    v_mul_f32 v33, v33, v81
    v_mul_f32 v34, v34, v82
    v_mul_f32 v35, v35, v83
    v_cvt_pk_bf16_f32 v32, v32, v33
    v_cvt_pk_bf16_f32 v33, v34, v35
    ds_write_b64 v4, v[32:33] offset:56320
    v_mov_b32 v36, 0
    v_mov_b32 v37, 0
    v_mov_b32 v38, 0
    v_mov_b32 v39, 0
    v_mov_b32 v40, 0
    v_mov_b32 v41, 0
    v_mov_b32 v42, 0
    v_mov_b32 v43, 0
    v_mov_b32 v44, 0
    v_mov_b32 v45, 0
    v_mov_b32 v46, 0
    v_mov_b32 v47, 0
    v_mov_b32 v48, 0
    v_mov_b32 v49, 0
    v_mov_b32 v50, 0
    v_mov_b32 v51, 0
    v_mov_b32 v52, 0
    v_mov_b32 v53, 0
    v_mov_b32 v54, 0
    v_mov_b32 v55, 0
    v_mov_b32 v56, 0
    v_mov_b32 v57, 0
    v_mov_b32 v58, 0
    v_mov_b32 v59, 0
    v_mov_b32 v60, 0
    v_mov_b32 v61, 0
    v_mov_b32 v62, 0
    v_mov_b32 v63, 0
    v_mov_b32 v64, 0
    v_mov_b32 v65, 0
    v_mov_b32 v66, 0
    v_mov_b32 v67, 0
    v_mov_b32 v68, 0
    v_mov_b32 v69, 0
    v_mov_b32 v70, 0
    v_mov_b32 v71, 0
    v_mov_b32 v72, 0
    v_mov_b32 v73, 0
    v_mov_b32 v74, 0
    v_mov_b32 v75, 0
    v_mov_b32 v76, 0
    v_mov_b32 v77, 0
    v_mov_b32 v78, 0
    v_mov_b32 v79, 0
    v_mov_b32 v80, 0
    v_mov_b32 v81, 0
    v_mov_b32 v82, 0
    v_mov_b32 v83, 0
    s_waitcnt lgkmcnt(0)
    s_lshr_b32 s36, s22, 2
    s_lshl_b32 s36, s36, 2
    s_add_u32 s36, s36, 148480
    v_mov_b32 v4, s36
    v_mov_b32 v5, 1
    s_mov_b64 exec, 1
    ds_add_u32 v4, v5
    s_mov_b64 exec, -1
    s_setprio 0
    s_mov_b32 s34, 1
    s_mov_b32 s35, 0
    v_add_u32 v7, 73728, v2
mega_E30_p1next:
    s_lshl_b32 s36, s35, 2
    s_add_u32 s36, s36, 148480
    v_mov_b32 v4, s36
mega_E30_wf:
    ds_read_b32 v5, v4
    s_waitcnt lgkmcnt(0)
    v_readfirstlane_b32 s36, v5
    s_cmp_ge_u32 s36, 4
    s_cbranch_scc1 mega_E30_wf_ok
    s_sleep 1
    s_branch mega_E30_wf
mega_E30_wf_ok:
    s_cmp_lt_u32 s35, 2
    s_cbranch_scc1 mega_E30_loop
    ds_read_b128 v[20:23], v7 offset:0
    ds_read_b128 v[24:27], v7 offset:18432
    ds_read_b128 v[28:31], v7 offset:36864
    ds_read_b128 v[32:35], v7 offset:55296
    s_waitcnt vmcnt(6)
    s_waitcnt lgkmcnt(3)
    v_mfma_f32_16x16x32_bf16 v[36:39], v[84:87], v[20:23], v[36:39]
    v_mfma_f32_16x16x32_bf16 v[52:55], v[88:91], v[20:23], v[52:55]
    v_mfma_f32_16x16x32_bf16 v[68:71], v[92:95], v[20:23], v[68:71]
    ds_read_b128 v[20:23], v7 offset:1024
    s_waitcnt lgkmcnt(3)
    v_mfma_f32_16x16x32_bf16 v[40:43], v[84:87], v[24:27], v[40:43]
    v_mfma_f32_16x16x32_bf16 v[56:59], v[88:91], v[24:27], v[56:59]
    v_mfma_f32_16x16x32_bf16 v[72:75], v[92:95], v[24:27], v[72:75]
    ds_read_b128 v[24:27], v7 offset:19456
    s_waitcnt lgkmcnt(3)
    v_mfma_f32_16x16x32_bf16 v[44:47], v[84:87], v[28:31], v[44:47]
    v_mfma_f32_16x16x32_bf16 v[60:63], v[88:91], v[28:31], v[60:63]
    v_mfma_f32_16x16x32_bf16 v[76:79], v[92:95], v[28:31], v[76:79]
    ds_read_b128 v[28:31], v7 offset:37888
    s_waitcnt lgkmcnt(3)
    v_mfma_f32_16x16x32_bf16 v[48:51], v[84:87], v[32:35], v[48:51]
    v_mfma_f32_16x16x32_bf16 v[64:67], v[88:91], v[32:35], v[64:67]
    v_mfma_f32_16x16x32_bf16 v[80:83], v[92:95], v[32:35], v[80:83]
    ds_read_b128 v[32:35], v7 offset:56320
    buffer_load_dwordx4 v[84:87], v2, s[12:15], s31 offen offset:0
    buffer_load_dwordx4 v[88:91], v2, s[12:15], s31 offen offset:1024
    buffer_load_dwordx4 v[92:95], v2, s[12:15], s31 offen offset:2048
    s_add_u32 s31, s31, 3072
    s_waitcnt vmcnt(6)
    s_waitcnt lgkmcnt(3)
    v_mfma_f32_16x16x32_bf16 v[36:39], v[96:99], v[20:23], v[36:39]
    v_mfma_f32_16x16x32_bf16 v[52:55], v[100:103], v[20:23], v[52:55]
    v_mfma_f32_16x16x32_bf16 v[68:71], v[104:107], v[20:23], v[68:71]
    ds_read_b128 v[20:23], v7 offset:2048
    s_waitcnt lgkmcnt(3)
    v_mfma_f32_16x16x32_bf16 v[40:43], v[96:99], v[24:27], v[40:43]
    v_mfma_f32_16x16x32_bf16 v[56:59], v[100:103], v[24:27], v[56:59]
    v_mfma_f32_16x16x32_bf16 v[72:75], v[104:107], v[24:27], v[72:75]
    ds_read_b128 v[24:27], v7 offset:20480
    s_waitcnt lgkmcnt(3)
    v_mfma_f32_16x16x32_bf16 v[44:47], v[96:99], v[28:31], v[44:47]
    v_mfma_f32_16x16x32_bf16 v[60:63], v[100:103], v[28:31], v[60:63]
    v_mfma_f32_16x16x32_bf16 v[76:79], v[104:107], v[28:31], v[76:79]
    ds_read_b128 v[28:31], v7 offset:38912
    s_waitcnt lgkmcnt(3)
    v_mfma_f32_16x16x32_bf16 v[48:51], v[96:99], v[32:35], v[48:51]
    v_mfma_f32_16x16x32_bf16 v[64:67], v[100:103], v[32:35], v[64:67]
    v_mfma_f32_16x16x32_bf16 v[80:83], v[104:107], v[32:35], v[80:83]
    ds_read_b128 v[32:35], v7 offset:57344
    buffer_load_dwordx4 v[96:99], v2, s[12:15], s31 offen offset:0
    buffer_load_dwordx4 v[100:103], v2, s[12:15], s31 offen offset:1024
    buffer_load_dwordx4 v[104:107], v2, s[12:15], s31 offen offset:2048
    s_add_u32 s31, s31, 3072
    s_waitcnt vmcnt(6)
    s_waitcnt lgkmcnt(3)
    v_mfma_f32_16x16x32_bf16 v[36:39], v[108:111], v[20:23], v[36:39]
    v_mfma_f32_16x16x32_bf16 v[52:55], v[112:115], v[20:23], v[52:55]
    v_mfma_f32_16x16x32_bf16 v[68:71], v[116:119], v[20:23], v[68:71]
    ds_read_b128 v[20:23], v7 offset:3072
    s_waitcnt lgkmcnt(3)
    v_mfma_f32_16x16x32_bf16 v[40:43], v[108:111], v[24:27], v[40:43]
    v_mfma_f32_16x16x32_bf16 v[56:59], v[112:115], v[24:27], v[56:59]
    v_mfma_f32_16x16x32_bf16 v[72:75], v[116:119], v[24:27], v[72:75]
    ds_read_b128 v[24:27], v7 offset:21504
    s_waitcnt lgkmcnt(3)
    v_mfma_f32_16x16x32_bf16 v[44:47], v[108:111], v[28:31], v[44:47]
    v_mfma_f32_16x16x32_bf16 v[60:63], v[112:115], v[28:31], v[60:63]
    v_mfma_f32_16x16x32_bf16 v[76:79], v[116:119], v[28:31], v[76:79]
    ds_read_b128 v[28:31], v7 offset:39936
    s_waitcnt lgkmcnt(3)
    v_mfma_f32_16x16x32_bf16 v[48:51], v[108:111], v[32:35], v[48:51]
    v_mfma_f32_16x16x32_bf16 v[64:67], v[112:115], v[32:35], v[64:67]
    v_mfma_f32_16x16x32_bf16 v[80:83], v[116:119], v[32:35], v[80:83]
    ds_read_b128 v[32:35], v7 offset:58368
    buffer_load_dwordx4 v[108:111], v2, s[12:15], s31 offen offset:0
    buffer_load_dwordx4 v[112:115], v2, s[12:15], s31 offen offset:1024
    buffer_load_dwordx4 v[116:119], v2, s[12:15], s31 offen offset:2048
    s_add_u32 s31, s31, 3072
    s_waitcnt vmcnt(6)
    s_waitcnt lgkmcnt(3)
    v_mfma_f32_16x16x32_bf16 v[36:39], v[84:87], v[20:23], v[36:39]
    v_mfma_f32_16x16x32_bf16 v[52:55], v[88:91], v[20:23], v[52:55]
    v_mfma_f32_16x16x32_bf16 v[68:71], v[92:95], v[20:23], v[68:71]
    ds_read_b128 v[20:23], v7 offset:4096
    s_waitcnt lgkmcnt(3)
    v_mfma_f32_16x16x32_bf16 v[40:43], v[84:87], v[24:27], v[40:43]
    v_mfma_f32_16x16x32_bf16 v[56:59], v[88:91], v[24:27], v[56:59]
    v_mfma_f32_16x16x32_bf16 v[72:75], v[92:95], v[24:27], v[72:75]
    ds_read_b128 v[24:27], v7 offset:22528
    s_waitcnt lgkmcnt(3)
    v_mfma_f32_16x16x32_bf16 v[44:47], v[84:87], v[28:31], v[44:47]
    v_mfma_f32_16x16x32_bf16 v[60:63], v[88:91], v[28:31], v[60:63]
    v_mfma_f32_16x16x32_bf16 v[76:79], v[92:95], v[28:31], v[76:79]
    ds_read_b128 v[28:31], v7 offset:40960
    s_waitcnt lgkmcnt(3)
    v_mfma_f32_16x16x32_bf16 v[48:51], v[84:87], v[32:35], v[48:51]
    v_mfma_f32_16x16x32_bf16 v[64:67], v[88:91], v[32:35], v[64:67]
    v_mfma_f32_16x16x32_bf16 v[80:83], v[92:95], v[32:35], v[80:83]
    ds_read_b128 v[32:35], v7 offset:59392
    s_waitcnt vmcnt(3)
    s_waitcnt lgkmcnt(3)
    v_mfma_f32_16x16x32_bf16 v[36:39], v[96:99], v[20:23], v[36:39]
    v_mfma_f32_16x16x32_bf16 v[52:55], v[100:103], v[20:23], v[52:55]
    v_mfma_f32_16x16x32_bf16 v[68:71], v[104:107], v[20:23], v[68:71]
    ds_read_b128 v[20:23], v7 offset:5120
    s_waitcnt lgkmcnt(3)
    v_mfma_f32_16x16x32_bf16 v[40:43], v[96:99], v[24:27], v[40:43]
    v_mfma_f32_16x16x32_bf16 v[56:59], v[100:103], v[24:27], v[56:59]
    v_mfma_f32_16x16x32_bf16 v[72:75], v[104:107], v[24:27], v[72:75]
    ds_read_b128 v[24:27], v7 offset:23552
    s_waitcnt lgkmcnt(3)
    v_mfma_f32_16x16x32_bf16 v[44:47], v[96:99], v[28:31], v[44:47]
    v_mfma_f32_16x16x32_bf16 v[60:63], v[100:103], v[28:31], v[60:63]
    v_mfma_f32_16x16x32_bf16 v[76:79], v[104:107], v[28:31], v[76:79]
    ds_read_b128 v[28:31], v7 offset:41984
    s_waitcnt lgkmcnt(3)
    v_mfma_f32_16x16x32_bf16 v[48:51], v[96:99], v[32:35], v[48:51]
    v_mfma_f32_16x16x32_bf16 v[64:67], v[100:103], v[32:35], v[64:67]
    v_mfma_f32_16x16x32_bf16 v[80:83], v[104:107], v[32:35], v[80:83]
    ds_read_b128 v[32:35], v7 offset:60416
    s_waitcnt vmcnt(0)
    s_waitcnt lgkmcnt(3)
    v_mfma_f32_16x16x32_bf16 v[36:39], v[108:111], v[20:23], v[36:39]
    v_mfma_f32_16x16x32_bf16 v[52:55], v[112:115], v[20:23], v[52:55]
    v_mfma_f32_16x16x32_bf16 v[68:71], v[116:119], v[20:23], v[68:71]
    s_waitcnt lgkmcnt(2)
    v_mfma_f32_16x16x32_bf16 v[40:43], v[108:111], v[24:27], v[40:43]
    v_mfma_f32_16x16x32_bf16 v[56:59], v[112:115], v[24:27], v[56:59]
    v_mfma_f32_16x16x32_bf16 v[72:75], v[116:119], v[24:27], v[72:75]
    s_waitcnt lgkmcnt(1)
    v_mfma_f32_16x16x32_bf16 v[44:47], v[108:111], v[28:31], v[44:47]
    v_mfma_f32_16x16x32_bf16 v[60:63], v[112:115], v[28:31], v[60:63]
    v_mfma_f32_16x16x32_bf16 v[76:79], v[116:119], v[28:31], v[76:79]
    s_waitcnt lgkmcnt(0)
    v_mfma_f32_16x16x32_bf16 v[48:51], v[108:111], v[32:35], v[48:51]
    v_mfma_f32_16x16x32_bf16 v[64:67], v[112:115], v[32:35], v[64:67]
    v_mfma_f32_16x16x32_bf16 v[80:83], v[116:119], v[32:35], v[80:83]
    s_nop 7
    s_lshl_b32 s36, s21, 5
    s_add_u32 s36, s36, s20
    s_mul_i32 s36, s36, 72
    s_mul_i32 s33, s22, 6
    s_add_u32 s36, s36, s33
    s_lshl_b32 s36, s36, 10
    v_cvt_pk_bf16_f32 v36, v36, v37
    v_cvt_pk_bf16_f32 v37, v38, v39
    v_cvt_pk_bf16_f32 v38, v40, v41
    v_cvt_pk_bf16_f32 v39, v42, v43
    buffer_store_dwordx4 v[36:39], v2, s[24:27], s36 offen offset:0 sc1
    v_cvt_pk_bf16_f32 v44, v44, v45
    v_cvt_pk_bf16_f32 v45, v46, v47
    v_cvt_pk_bf16_f32 v46, v48, v49
    v_cvt_pk_bf16_f32 v47, v50, v51
    buffer_store_dwordx4 v[44:47], v2, s[24:27], s36 offen offset:1024 sc1
    v_cvt_pk_bf16_f32 v52, v52, v53
    v_cvt_pk_bf16_f32 v53, v54, v55
    v_cvt_pk_bf16_f32 v54, v56, v57
    v_cvt_pk_bf16_f32 v55, v58, v59
    buffer_store_dwordx4 v[52:55], v2, s[24:27], s36 offen offset:2048 sc1
    v_cvt_pk_bf16_f32 v60, v60, v61
    v_cvt_pk_bf16_f32 v61, v62, v63
    v_cvt_pk_bf16_f32 v62, v64, v65
    v_cvt_pk_bf16_f32 v63, v66, v67
    buffer_store_dwordx4 v[60:63], v2, s[24:27], s36 offen offset:3072 sc1
    v_cvt_pk_bf16_f32 v68, v68, v69
    v_cvt_pk_bf16_f32 v69, v70, v71
    v_cvt_pk_bf16_f32 v70, v72, v73
    v_cvt_pk_bf16_f32 v71, v74, v75
    s_add_u32 s36, s36, 4096
    buffer_store_dwordx4 v[68:71], v2, s[24:27], s36 offen offset:0 sc1
    v_cvt_pk_bf16_f32 v76, v76, v77
    v_cvt_pk_bf16_f32 v77, v78, v79
    v_cvt_pk_bf16_f32 v78, v80, v81
    v_cvt_pk_bf16_f32 v79, v82, v83
    buffer_store_dwordx4 v[76:79], v2, s[24:27], s36 offen offset:1024 sc1
    s_waitcnt vmcnt(0)
    s_barrier
    s_cmp_lg_u32 s22, 0
    s_cbranch_scc1 mega_sg33
    s_add_u32 s82, s20, 96
    s_lshl_b32 s82, s82, 7
    v_mov_b32 v110, s82
    v_mov_b32 v111, 1
    s_mov_b64 exec, 1
    buffer_atomic_add v111, v110, s[84:87], 0 offen sc1
mega_sg33:
    s_mov_b64 exec, -1
    v_and_b32 v1, 63, v0
    v_lshlrev_b32 v2, 4, v1
    v_and_b32 v3, 15, v1
    v_lshrrev_b32 v4, 4, v1
    s_and_b32 s21, s2, 7
    s_lshr_b32 s23, s2, 3
    s_lshr_b32 s20, s21, 2
    s_lshl_b32 s20, s20, 4
    s_and_b32 s19, s23, 15
    s_add_u32 s20, s20, s19
    s_and_b32 s21, s21, 3
    s_lshl_b32 s21, s21, 1
    s_lshr_b32 s23, s23, 4
    s_add_u32 s21, s21, s23
    s_mul_i32 s24, s21, 9
    s_add_u32 s24, s24, s22
    s_lshr_b32 s25, s24, 1
    s_and_b32 s26, s24, 1
    s_lshl_b32 s27, s20, 2
    s_lshl_b32 s28, s26, 1
    s_add_u32 s27, s27, s28
    s_mul_i32 s28, s27, 72
    s_lshl_b32 s29, s25, 1
    s_add_u32 s28, s28, s29
    s_lshl_b32 s28, s28, 8
    v_lshrrev_b32 v5, 5, v1
    v_lshlrev_b32 v5, 8, v5
    v_lshl_add_u32 v5, v3, 4, v5
    v_bfe_u32 v6, v1, 4, 1
    v_lshl_add_u32 v5, v6, 3, v5
    s_add_u32 s12, s4, 0xc60000
    s_addc_u32 s13, s5, 0
    s_mov_b32 s14, 0x240000
    s_mov_b32 s15, 0x20000
    s_cmp_ge_u32 s22, 9
    s_cbranch_scc1 mega_G34_w
    buffer_load_dwordx2 v[8:9], v5, s[12:15], s28 offen sc1
    s_add_u32 s28, s28, 18432
    buffer_load_dwordx2 v[10:11], v5, s[12:15], s28 offen sc1
mega_G34_w:
    s_add_u32 s33, s20, 96
    s_waitcnt vmcnt(0)
    s_cmp_lg_u32 s22, 0
    s_cbranch_scc1 mega_wc35
    v_and_b32 v1, 63, v0
    v_add_u32 v2, s33, v1
    v_lshlrev_b32 v1, 7, v2
    s_mov_b32 exec_lo, 0x1
    s_mov_b32 exec_hi, 0x0
    s_mov_b32 s82, 0
mega_pl36:
    buffer_load_dword v2, v1, s[84:87], 0 offen sc1
    s_waitcnt vmcnt(0)
    v_cmp_gt_u32 vcc, 8, v2
    s_add_u32 s82, s82, 1
    s_cmp_gt_u32 s82, 400000
    s_cbranch_scc1 mega_pl36_x
    s_cbranch_vccz mega_pl36_x
    s_sleep 1
    s_branch mega_pl36
mega_pl36_x:
    s_mov_b64 exec, -1
mega_wc35:
    s_barrier
    v_and_b32 v1, 63, v0
    v_lshlrev_b32 v2, 4, v1
    v_and_b32 v3, 15, v1
    v_lshrrev_b32 v4, 4, v1
    s_cmp_ge_u32 s22, 9
    s_cbranch_scc1 mega_G34_end
    s_add_u32 s8, s4, 0xee0000
    s_addc_u32 s9, s5, 0
    s_mov_b32 s10, 0x1200000
    s_mov_b32 s11, 0x20000
    s_mov_b32 s16, s76
    s_mov_b32 s17, s77
    s_mov_b32 s18, 0x240000
    s_mov_b32 s19, 0x20000
    s_mul_i32 s30, s20, 72
    s_add_u32 s30, s30, s24
    s_lshl_b32 s30, s30, 10
    buffer_load_dwordx4 v[12:15], v2, s[8:11], s30 offen sc1
    s_add_u32 s30, s30, 2359296
    buffer_load_dwordx4 v[16:19], v2, s[8:11], s30 offen sc1
    s_add_u32 s30, s30, 2359296
    buffer_load_dwordx4 v[20:23], v2, s[8:11], s30 offen sc1
    s_add_u32 s30, s30, 2359296
    buffer_load_dwordx4 v[24:27], v2, s[8:11], s30 offen sc1
    s_add_u32 s30, s30, 2359296
    buffer_load_dwordx4 v[28:31], v2, s[8:11], s30 offen sc1
    s_add_u32 s30, s30, 2359296
    buffer_load_dwordx4 v[32:35], v2, s[8:11], s30 offen sc1
    s_add_u32 s30, s30, 2359296
    buffer_load_dwordx4 v[36:39], v2, s[8:11], s30 offen sc1
    s_add_u32 s30, s30, 2359296
    buffer_load_dwordx4 v[40:43], v2, s[8:11], s30 offen sc1
    s_lshl_b32 s27, s27, 4
    v_add_u32 v6, s27, v3
    v_mul_u32_u24 v6, 1152, v6
    s_lshl_b32 s25, s25, 5
    v_lshl_add_u32 v6, v4, 3, v6
    v_add_u32 v6, s25, v6
    v_add_u32 v7, 18432, v6
    v_lshlrev_b32 v48, 16, v8
    v_and_b32 v49, 0xffff0000, v8
    v_lshlrev_b32 v50, 16, v9
    v_and_b32 v51, 0xffff0000, v9
    v_lshlrev_b32 v52, 16, v10
    v_and_b32 v53, 0xffff0000, v10
    v_lshlrev_b32 v54, 16, v11
    v_and_b32 v55, 0xffff0000, v11
    s_waitcnt vmcnt(7)
    v_lshlrev_b32 v56, 16, v12
    v_and_b32 v57, 0xffff0000, v12
    v_add_f32 v48, v48, v56
    v_add_f32 v49, v49, v57
    v_lshlrev_b32 v56, 16, v13
    v_and_b32 v57, 0xffff0000, v13
    v_add_f32 v50, v50, v56
    v_add_f32 v51, v51, v57
    v_lshlrev_b32 v56, 16, v14
    v_and_b32 v57, 0xffff0000, v14
    v_add_f32 v52, v52, v56
    v_add_f32 v53, v53, v57
    v_lshlrev_b32 v56, 16, v15
    v_and_b32 v57, 0xffff0000, v15
    v_add_f32 v54, v54, v56
    v_add_f32 v55, v55, v57
    s_waitcnt vmcnt(6)
    v_lshlrev_b32 v56, 16, v16
    v_and_b32 v57, 0xffff0000, v16
    v_add_f32 v48, v48, v56
    v_add_f32 v49, v49, v57
    v_lshlrev_b32 v56, 16, v17
    v_and_b32 v57, 0xffff0000, v17
    v_add_f32 v50, v50, v56
    v_add_f32 v51, v51, v57
    v_lshlrev_b32 v56, 16, v18
    v_and_b32 v57, 0xffff0000, v18
    v_add_f32 v52, v52, v56
    v_add_f32 v53, v53, v57
    v_lshlrev_b32 v56, 16, v19
    v_and_b32 v57, 0xffff0000, v19
    v_add_f32 v54, v54, v56
    v_add_f32 v55, v55, v57
    s_waitcnt vmcnt(5)
    v_lshlrev_b32 v56, 16, v20
    v_and_b32 v57, 0xffff0000, v20
    v_add_f32 v48, v48, v56
    v_add_f32 v49, v49, v57
    v_lshlrev_b32 v56, 16, v21
    v_and_b32 v57, 0xffff0000, v21
    v_add_f32 v50, v50, v56
    v_add_f32 v51, v51, v57
    v_lshlrev_b32 v56, 16, v22
    v_and_b32 v57, 0xffff0000, v22
    v_add_f32 v52, v52, v56
    v_add_f32 v53, v53, v57
    v_lshlrev_b32 v56, 16, v23
    v_and_b32 v57, 0xffff0000, v23
    v_add_f32 v54, v54, v56
    v_add_f32 v55, v55, v57
    s_waitcnt vmcnt(4)
    v_lshlrev_b32 v56, 16, v24
    v_and_b32 v57, 0xffff0000, v24
    v_add_f32 v48, v48, v56
    v_add_f32 v49, v49, v57
    v_lshlrev_b32 v56, 16, v25
    v_and_b32 v57, 0xffff0000, v25
    v_add_f32 v50, v50, v56
    v_add_f32 v51, v51, v57
    v_lshlrev_b32 v56, 16, v26
    v_and_b32 v57, 0xffff0000, v26
    v_add_f32 v52, v52, v56
    v_add_f32 v53, v53, v57
    v_lshlrev_b32 v56, 16, v27
    v_and_b32 v57, 0xffff0000, v27
    v_add_f32 v54, v54, v56
    v_add_f32 v55, v55, v57
    s_waitcnt vmcnt(3)
    v_lshlrev_b32 v56, 16, v28
    v_and_b32 v57, 0xffff0000, v28
    v_add_f32 v48, v48, v56
    v_add_f32 v49, v49, v57
    v_lshlrev_b32 v56, 16, v29
    v_and_b32 v57, 0xffff0000, v29
    v_add_f32 v50, v50, v56
    v_add_f32 v51, v51, v57
    v_lshlrev_b32 v56, 16, v30
    v_and_b32 v57, 0xffff0000, v30
    v_add_f32 v52, v52, v56
    v_add_f32 v53, v53, v57
    v_lshlrev_b32 v56, 16, v31
    v_and_b32 v57, 0xffff0000, v31
    v_add_f32 v54, v54, v56
    v_add_f32 v55, v55, v57
    s_waitcnt vmcnt(2)
    v_lshlrev_b32 v56, 16, v32
    v_and_b32 v57, 0xffff0000, v32
    v_add_f32 v48, v48, v56
    v_add_f32 v49, v49, v57
    v_lshlrev_b32 v56, 16, v33
    v_and_b32 v57, 0xffff0000, v33
    v_add_f32 v50, v50, v56
    v_add_f32 v51, v51, v57
    v_lshlrev_b32 v56, 16, v34
    v_and_b32 v57, 0xffff0000, v34
    v_add_f32 v52, v52, v56
    v_add_f32 v53, v53, v57
    v_lshlrev_b32 v56, 16, v35
    v_and_b32 v57, 0xffff0000, v35
    v_add_f32 v54, v54, v56
    v_add_f32 v55, v55, v57
    s_waitcnt vmcnt(1)
    v_lshlrev_b32 v56, 16, v36
    v_and_b32 v57, 0xffff0000, v36
    v_add_f32 v48, v48, v56
    v_add_f32 v49, v49, v57
    v_lshlrev_b32 v56, 16, v37
    v_and_b32 v57, 0xffff0000, v37
    v_add_f32 v50, v50, v56
    v_add_f32 v51, v51, v57
    v_lshlrev_b32 v56, 16, v38
    v_and_b32 v57, 0xffff0000, v38
    v_add_f32 v52, v52, v56
    v_add_f32 v53, v53, v57
    v_lshlrev_b32 v56, 16, v39
    v_and_b32 v57, 0xffff0000, v39
    v_add_f32 v54, v54, v56
    v_add_f32 v55, v55, v57
    s_waitcnt vmcnt(0)
    v_lshlrev_b32 v56, 16, v40
    v_and_b32 v57, 0xffff0000, v40
    v_add_f32 v48, v48, v56
    v_add_f32 v49, v49, v57
    v_lshlrev_b32 v56, 16, v41
    v_and_b32 v57, 0xffff0000, v41
    v_add_f32 v50, v50, v56
    v_add_f32 v51, v51, v57
    v_lshlrev_b32 v56, 16, v42
    v_and_b32 v57, 0xffff0000, v42
    v_add_f32 v52, v52, v56
    v_add_f32 v53, v53, v57
    v_lshlrev_b32 v56, 16, v43
    v_and_b32 v57, 0xffff0000, v43
    v_add_f32 v54, v54, v56
    v_add_f32 v55, v55, v57
    v_cvt_pk_bf16_f32 v8, v48, v49
    v_cvt_pk_bf16_f32 v9, v50, v51
    v_cvt_pk_bf16_f32 v10, v52, v53
    v_cvt_pk_bf16_f32 v11, v54, v55
    buffer_store_dwordx2 v[8:9], v6, s[16:19], 0 offen
    buffer_store_dwordx2 v[10:11], v7, s[16:19], 0 offen
mega_G34_end:
mega_done:
    s_endpgm
mega_end:
.section .rodata,"a"
.p2align 6
.amdhsa_kernel sequential_preLN__linear_attn_block__mixer_s_mlp__prompt_kernel
  .amdhsa_next_free_vgpr 168
  .amdhsa_next_free_sgpr 96
  .amdhsa_accum_offset 168
  .amdhsa_group_segment_fixed_size 0
  .amdhsa_kernarg_size 88
  .amdhsa_user_sgpr_count 2
  .amdhsa_user_sgpr_kernarg_segment_ptr 1
  .amdhsa_system_sgpr_workgroup_id_x 1
  .amdhsa_system_sgpr_workgroup_id_y 0
  .amdhsa_float_denorm_mode_32 3
.end_amdhsa_kernel
```
